```python
import torch

def _softmax(x, axis=-1):
    return torch.softmax(x, dim=axis)
def _gelu(x):
    return torch.nn.functional.gelu(x, approximate="tanh")
def _silu(x):
    return torch.nn.functional.silu(x)
def _sigmoid(x):
    return torch.sigmoid(x)
def _layernorm(x, axis=-1, eps=1e-5):
    m = x.mean(dim=axis, keepdim=True)
    v = x.var(dim=axis, keepdim=True, unbiased=False)
    return (x - m) / torch.sqrt(v + eps)
def _scatter_add(tgt, idx, src, axis=0):
    return tgt.clone().index_add_(axis, idx, src)
def _segment_sum(src, seg, n):
    out = torch.zeros((n,) + src.shape[1:], dtype=src.dtype)
    return out.index_add_(0, seg, src)
def _pad(x, pw):
    flat = tuple(v for pair in reversed(pw) for v in pair)
    return torch.nn.functional.pad(x, flat)

kernel_name = 'concat_heads__gqa_block_cached__gqa_block_cached__near_ridge'

def setup_inputs():

    _w = (lambda a: (lambda t: t.to(torch.bfloat16) if t.is_floating_point() else t)(torch.as_tensor(a)))
    def _A_setup():
        B, Sq, D = 32, 32, 448
        Hq, Hkv, Sk, Dh = 16, 8, 32, 256
        assert Hq % Hkv == 0, (Hq, Hkv)
        return {
            "x": _w((lambda *s: torch.randn(*s, dtype=torch.bfloat16) * 0.8)(B, Sq, D)),
            "k_cache": _w((lambda *s: torch.randn(*s, dtype=torch.bfloat16) * 0.8)(B, Hkv, Sk, Dh)),
            "v_cache": _w((lambda *s: torch.randn(*s, dtype=torch.bfloat16) * 0.05)(B, Hkv, Sk, Dh)),
            "wq": _w((lambda *s: torch.randn(*s, dtype=torch.bfloat16) * 0.8)(D, Hq * Dh) * (D ** -0.5)),
            "wo": _w((lambda *s: torch.randn(*s, dtype=torch.bfloat16) * 0.05)(Hq * Dh, D) * ((Hq * Dh) ** -0.5)),
        }
    _A_in = _A_setup()

    def _B_setup():
        B, Sq, D = 32, 32, 448
        Hq, Hkv, Sk, Dh = 16, 8, 32, 256
        assert Hq % Hkv == 0, (Hq, Hkv)
        return {
            "x": _w((lambda *s: torch.randn(*s, dtype=torch.bfloat16) * 0.8)(B, Sq, D)),
            "k_cache": _w((lambda *s: torch.randn(*s, dtype=torch.bfloat16) * 0.8)(B, Hkv, Sk, Dh)),
            "v_cache": _w((lambda *s: torch.randn(*s, dtype=torch.bfloat16) * 0.05)(B, Hkv, Sk, Dh)),
            "wq": _w((lambda *s: torch.randn(*s, dtype=torch.bfloat16) * 0.8)(D, Hq * Dh) * (D ** -0.5)),
            "wo": _w((lambda *s: torch.randn(*s, dtype=torch.bfloat16) * 0.05)(Hq * Dh, D) * ((Hq * Dh) ** -0.5)),
        }
    _B_in = _B_setup()

    return {
        "A_x": _A_in["x"],
        "A_k_cache": _A_in["k_cache"],
        "A_v_cache": _A_in["v_cache"],
        "A_wq": _A_in["wq"],
        "A_wo": _A_in["wo"],
        "B_x": _B_in["x"],
        "B_k_cache": _B_in["k_cache"],
        "B_v_cache": _B_in["v_cache"],
        "B_wq": _B_in["wq"],
        "B_wo": _B_in["wo"],
    }

def reference(A_x, A_k_cache, A_v_cache, A_wq, A_wo, B_x, B_k_cache, B_v_cache, B_wq, B_wo):
    def _A_ref(x, k_cache, v_cache, wq, wo):
        B, Sq, D = x.shape
        Hq, Dh = 16, 256
        Hkv = k_cache.shape[1]
        rep = Hq // Hkv
        q = (lambda x, *d: x.permute(*d))((x @ wq).reshape(B, Sq, Hq, Dh), 0, 2, 1, 3)
        k = (lambda x, n, axis: torch.repeat_interleave(x, n, dim=axis))(k_cache, rep, axis=1)
        v = (lambda x, n, axis: torch.repeat_interleave(x, n, dim=axis))(v_cache, rep, axis=1)
        scores = torch.einsum("bhqd,bhkd->bhqk", q, k) * (Dh ** -0.5)
        p = _softmax(scores, axis=-1)
        o = torch.einsum("bhqk,bhkd->bhqd", p, v)
        return (lambda x, *d: x.permute(*d))(o, 0, 2, 1, 3).reshape(B, Sq, Hq * Dh) @ wo

    def _B_ref(x, k_cache, v_cache, wq, wo):
        B, Sq, D = x.shape
        Hq, Dh = 16, 256
        Hkv = k_cache.shape[1]
        rep = Hq // Hkv
        q = (lambda x, *d: x.permute(*d))((x @ wq).reshape(B, Sq, Hq, Dh), 0, 2, 1, 3)
        k = (lambda x, n, axis: torch.repeat_interleave(x, n, dim=axis))(k_cache, rep, axis=1)
        v = (lambda x, n, axis: torch.repeat_interleave(x, n, dim=axis))(v_cache, rep, axis=1)
        scores = torch.einsum("bhqd,bhkd->bhqk", q, k) * (Dh ** -0.5)
        p = _softmax(scores, axis=-1)
        o = torch.einsum("bhqk,bhkd->bhqd", p, v)
        return (lambda x, *d: x.permute(*d))(o, 0, 2, 1, 3).reshape(B, Sq, Hq * Dh) @ wo

    a = _A_ref(A_x, A_k_cache, A_v_cache, A_wq, A_wo)
    b = _B_ref(B_x, B_k_cache, B_v_cache, B_wq, B_wo)
    return torch.concatenate([a, b], axis=-1)
```

```asm
; @launch grid=(256,1,1) block=(256,1,1) lds=163840
.amdgcn_target "amdgcn-amd-amdhsa--gfx950"
.text
.globl concat_heads__gqa_block_cached__gqa_block_cached__near_ridge_kernel
.p2align 8
.type concat_heads__gqa_block_cached__gqa_block_cached__near_ridge_kernel,@function
concat_heads__gqa_block_cached__gqa_block_cached__near_ridge_kernel:
    s_cmp_ge_u32 s2, 256
    s_cbranch_scc1 L_end
    s_load_dwordx16 s[8:23], s[0:1], 0
    s_load_dwordx4 s[24:27], s[0:1], 64
    s_load_dwordx4 s[28:31], s[0:1], 80
    s_load_dwordx2 s[32:33], s[0:1], 96
    s_getpc_b64 s[68:69]
    s_mov_b32 s70, 32768
    s_mov_b32 s71, 0x20000
    s_and_b32 s3, s2, 0xfffffff8
    v_lshrrev_b32 v20, 5, v0
    v_add_u32 v20, s3, v20
    v_lshlrev_b32 v20, 7, v20
    buffer_load_dword v239, v20, s[68:71], 0 offen
    v_lshrrev_b32 v1, 6, v0
    v_and_b32 v2, 63, v0
    s_and_b32 s89, s2, 3
    s_bfe_u32 s34, s2, 0x10002
    s_lshr_b32 s35, s2, 3
    v_readfirstlane_b32 s4, v1
    s_and_b32 s3, s35, 3
    s_lshl_b32 s85, s89, 2
    s_add_u32 s85, s85, s3
    s_lshr_b32 s86, s35, 2
    s_add_u32 s3, s3, s86
    s_and_b32 s3, s3, 3
    s_mul_i32 s73, s3, 2
    s_mov_b32 s74, s73
    v_lshrrev_b32 v5, 4, v2
    v_lshrrev_b32 v9, 3, v2
    v_and_b32 v10, 7, v2
    v_lshrrev_b32 v7, 5, v2
    v_and_b32 v8, 31, v2
    v_xor_b32 v11, v10, v5
    v_lshlrev_b32 v11, 4, v11
    v_xor_b32 v3, 64, v11
    s_lshl_b32 s3, s4, 5
    v_add_u32 v12, s3, v9
    v_mul_u32_u24 v12, 896, v12
    v_add_u32 v172, v11, v12
    v_add_u32 v13, v3, v12
    v_add_u32 v173, 6144, v13
    v_add_u32 v174, 12288, v172
    v_add_u32 v175, 18432, v13
    s_lshl_b32 s3, s4, 3
    v_lshlrev_b32 v13, 2, v7
    v_xor_b32 v13, v8, v13
    v_lshlrev_b32 v13, 4, v13
    v_add_u32 v12, s3, v7
    v_lshl_add_u32 v176, v12, 13, v13
    v_xor_b32 v13, 128, v13
    v_lshl_add_u32 v14, v12, 13, v13
    v_add_u32 v177, 15360, v14
    v_add_u32 v178, 30720, v176
    v_add_u32 v179, 46080, v14
    s_lshl_b32 s72, s4, 12
    s_waitcnt lgkmcnt(0)
    s_cmp_eq_u32 s34, 0
    s_cselect_b32 s36, s8, s18
    s_cselect_b32 s37, s9, s19
    s_cselect_b32 s40, s14, s24
    s_cselect_b32 s41, s15, s25
    s_mul_i32 s3, s86, 114688
    s_add_u32 s36, s36, s3
    s_addc_u32 s37, s37, 0
    s_sub_u32 s38, 917504, s3
    s_mov_b32 s39, 0x20000
    s_lshl_b32 s3, s85, 9
    s_add_u32 s40, s40, s3
    s_addc_u32 s41, s41, 0
    s_sub_u32 s42, 3670016, s3
    s_mov_b32 s43, 0x20000
    s_add_u32 m0, s72, 98304
    s_lshl_b32 s77, s74, 7
    s_add_u32 s74, s74, 1
    s_cmp_eq_u32 s74, 7
    s_cselect_b32 s74, 0, s74
    buffer_load_dwordx4 v172, s[36:39], s77 offen lds
    buffer_load_dwordx4 v173, s[36:39], s77 offen offset:1024 lds
    s_add_u32 m0, s72, 98304
    s_nop 0
    buffer_load_dwordx4 v174, s[36:39], s77 offen offset:2048 lds
    buffer_load_dwordx4 v175, s[36:39], s77 offen offset:3072 lds
    s_add_u32 m0, s72, 0
    s_lshl_b32 s75, s73, 19
    buffer_load_dwordx4 v176, s[40:43], s75 offen lds
    buffer_load_dwordx4 v177, s[40:43], s75 offen offset:1024 lds
    buffer_load_dwordx4 v178, s[40:43], s75 offen offset:2048 lds
    buffer_load_dwordx4 v179, s[40:43], s75 offen offset:3072 lds
    s_mov_b32 s64, s30
    s_mov_b32 s65, s31
    s_mov_b32 s66, 256
    s_mov_b32 s67, 0x20000
    v_mov_b32 v242, 0
    s_or_b32 s3, s2, s4
    s_cmp_lg_u32 s3, 0
    s_cbranch_scc1 L_nononce
    s_memrealtime s[18:19]
    s_waitcnt lgkmcnt(0)
    s_or_b32 s18, s18, 1
    s_or_b32 s19, s19, 0x40000000
    v_mov_b32 v250, s18
    v_mov_b32 v251, s19
    s_mov_b64 exec, 1
    buffer_store_dwordx2 v[250:251], v242, s[64:67], 0 offen sc1
    s_mov_b64 exec, -1
L_nononce:
    s_cmp_eq_u32 s34, 0
    s_cselect_b32 s44, s10, s20
    s_cselect_b32 s45, s11, s21
    s_cselect_b32 s48, s12, s22
    s_cselect_b32 s49, s13, s23
    s_cselect_b32 s52, s16, s26
    s_cselect_b32 s53, s17, s27
    s_and_b32 s5, s4, 1
    s_lshr_b32 s6, s4, 1
    v_lshrrev_b32 v12, 1, v8
    v_and_b32 v12, 7, v12
    v_xor_b32 v12, v12, v7
    v_lshlrev_b32 v12, 4, v12
    v_lshl_add_u32 v12, v8, 7, v12
    s_lshl_b32 s3, s6, 13
    s_lshl_b32 s7, s5, 12
    s_add_u32 s7, s7, s3
    s_add_u32 s7, s7, 98304
    v_add_u32 v160, s7, v12
    s_xor_b32 s7, s7, 4096
    v_add_u32 v164, s7, v12
    v_xor_b32 v161, 32, v160
    v_xor_b32 v162, 64, v160
    v_xor_b32 v163, 96, v160
    v_xor_b32 v165, 32, v164
    v_xor_b32 v166, 64, v164
    v_xor_b32 v167, 96, v164
    v_lshrrev_b32 v13, 2, v2
    v_and_b32 v13, 3, v13
    v_and_b32 v14, 1, v5
    v_and_b32 v15, 1, v2
    v_lshl_add_u32 v15, v14, 1, v15
    v_lshrrev_b32 v16, 1, v2
    v_and_b32 v16, 1, v16
    v_lshlrev_b32 v16, 3, v16
    v_lshl_add_u32 v16, v15, 4, v16
    v_lshl_add_u32 v17, v7, 3, v13
    s_lshl_b32 s3, s5, 8
    v_lshl_add_u32 v18, v17, 9, v16
    v_add_u32 v18, s3, v18
    s_and_b32 s3, s85, 1
    s_lshl_b32 s21, s3, 7
    s_lshl_b32 s3, s3, 1
    v_xor_b32 v20, s3, v13
    v_xor_b32 v19, 0, v20
    v_lshl_add_u32 v168, v19, 6, v18
    v_xor_b32 v19, 1, v20
    v_lshl_add_u32 v169, v19, 6, v18
    v_xor_b32 v19, 2, v20
    v_lshl_add_u32 v170, v19, 6, v18
    v_xor_b32 v19, 3, v20
    v_lshl_add_u32 v171, v19, 6, v18
    s_add_u32 m0, s72, 16384
    s_lshl_b32 s76, s73, 19
    s_add_u32 s76, s76, 262144
    s_add_u32 s73, s73, 1
    s_cmp_eq_u32 s73, 7
    s_cselect_b32 s73, 0, s73
    buffer_load_dwordx4 v176, s[40:43], s76 offen lds
    buffer_load_dwordx4 v177, s[40:43], s76 offen offset:1024 lds
    buffer_load_dwordx4 v178, s[40:43], s76 offen offset:2048 lds
    buffer_load_dwordx4 v179, s[40:43], s76 offen offset:3072 lds
    s_add_u32 s3, s72, 147456
    v_add_u32 v180, s3, v12
    v_xor_b32 v181, 32, v180
    v_xor_b32 v182, 64, v180
    v_xor_b32 v183, 96, v180
    v_add_u32 v220, s72, v12
    v_xor_b32 v221, 32, v220
    v_xor_b32 v222, 64, v220
    v_xor_b32 v223, 96, v220
    s_lshl_b32 s3, s6, 13
    v_lshl_add_u32 v18, v17, 7, v16
    v_add_u32 v18, s3, v18
    v_lshrrev_b32 v19, 1, v13
    v_xor_b32 v19, s6, v19
    v_lshl_add_u32 v228, v19, 6, v18
    v_xor_b32 v229, 64, v228
    v_lshlrev_b32 v12, 9, v9
    v_add_u32 v216, v11, v12
    v_add_u32 v13, v3, v12
    v_add_u32 v217, 3072, v13
    v_add_u32 v218, 6144, v216
    v_add_u32 v219, 9216, v13
    s_lshl_b32 s3, s86, 5
    s_lshr_b32 s7, s85, 1
    s_add_u32 s3, s3, s7
    s_lshl_b32 s3, s3, 14
    s_add_u32 s44, s44, s3
    s_addc_u32 s45, s45, 0
    s_sub_u32 s46, 4194304, s3
    s_mov_b32 s47, 0x20000
    s_lshl_b32 s3, s6, 1
    s_add_u32 s7, s3, s5
    s_lshl_b32 s79, s7, 17
    s_xor_b32 s7, s7, 1
    s_lshl_b32 s80, s7, 17
    s_lshl_b32 s3, s5, 8
    s_add_u32 s79, s79, s3
    s_add_u32 s80, s80, s3
    s_mov_b32 s56, s32
    s_mov_b32 s57, s33
    s_mov_b32 s58, 33554432
    s_mov_b32 s59, 0x20000
    v_lshlrev_b32 v234, 4, v2
    s_mul_i32 s16, s2, 12
    s_add_u32 s16, s16, s4
    s_lshl_b32 s16, s16, 11
    s_add_u32 s16, s16, 8388608
    s_lshl_b32 s84, s2, 7
    s_add_u32 s84, s84, 6291456
    s_lshl_b32 s17, s2, 2
    s_add_u32 s17, s17, s4
    s_lshl_b32 s17, s17, 7
    s_add_u32 s17, s17, 6356992
    v_mov_b32 v200, -1
    v_mov_b32 v201, -1
    v_mov_b32 v202, -1
    v_mov_b32 v203, -1
    s_and_b32 s87, s35, 3
    s_lshr_b32 s88, s35, 2
    s_cmp_ge_u32 s35, 28
    s_cselect_b32 s81, 1, 0
    s_cselect_b32 s88, 0, s88
    s_add_u32 s96, s87, s88
    s_and_b32 s96, s96, 3
    s_add_u32 s98, s89, 1
    s_and_b32 s98, s98, 3
    s_add_u32 s99, s89, 2
    s_and_b32 s99, s99, 3
    s_add_u32 s100, s89, 3
    s_and_b32 s100, s100, 3
    s_add_u32 s101, s89, 4
    s_and_b32 s101, s101, 3
    s_lshl_b32 s3, s87, 20
    s_add_u32 s48, s48, s3
    s_addc_u32 s49, s49, 0
    s_sub_u32 s50, 4194304, s3
    s_mov_b32 s51, 0x20000
    s_lshl_b32 s3, s89, 1
    s_add_u32 s3, s3, s6
    s_lshl_b32 s3, s3, 14
    s_lshl_b32 s7, s5, 17
    s_add_u32 s97, s3, s7
    s_lshl_b32 s3, s88, 7
    s_add_u32 s52, s52, s3
    s_addc_u32 s53, s53, 0
    s_sub_u32 s54, 3670016, s3
    s_mov_b32 s55, 0x20000
    s_cmp_eq_u32 s81, 1
    s_cselect_b32 s50, 0, s50
    s_cselect_b32 s54, 0, s54
    s_lshl_b32 s3, s89, 2
    s_add_u32 s3, s3, s4
    s_lshl_b32 s3, s3, 8
    v_add_u32 v12, s3, v9
    v_mul_u32_u24 v12, 896, v12
    v_lshlrev_b32 v13, 2, v14
    v_xor_b32 v13, v10, v13
    v_lshl_add_u32 v230, v13, 4, v12
    v_add_u32 v231, 6144, v230
    v_add_u32 v232, 12288, v230
    v_add_u32 v233, 18432, v230
    s_lshl_b32 s3, s86, 2
    s_add_u32 s3, s3, s4
    s_lshl_b32 s3, s3, 4
    s_add_u32 s3, s3, s85
    s_lshl_b32 s82, s3, 11
    s_lshl_b32 s3, s34, 20
    s_add_u32 s82, s82, s3
    s_lshl_b32 s7, s87, 3
    s_add_u32 s7, s7, s5
    s_lshl_b32 s7, s7, 3
    s_lshl_b32 s83, s89, 1
    s_add_u32 s83, s83, s6
    s_add_u32 s83, s83, s7
    s_lshl_b32 s83, s83, 12
    s_add_u32 s83, s83, s3
    s_lshl_b32 s3, s87, 2
    s_add_u32 s3, s3, s89
    s_mul_i32 s3, s3, 114688
    s_mul_i32 s7, s34, 896
    s_add_u32 s3, s3, s7
    s_lshl_b32 s7, s88, 7
    s_add_u32 s3, s3, s7
    s_add_u32 s60, s28, s3
    s_addc_u32 s61, s29, 0
    s_sub_u32 s62, 1835008, s3
    s_mov_b32 s63, 0x20000
    s_lshl_b32 s3, s5, 5
    v_add_u32 v12, s3, v8
    v_mul_u32_u24 v12, 1792, v12
    s_lshl_b32 s3, s6, 6
    v_lshl_add_u32 v13, v7, 4, s3
    v_add_u32 v235, v12, v13
    s_add_u32 s3, s72, 147456
    v_add_u32 v236, s3, v234
    v_xor_b32 v237, 4096, v236
    v_xor_b32 v238, 8192, v236
    s_mov_b32 s12, 0
    s_mov_b32 s13, 0
    s_mov_b32 s14, 0
    s_lshl_b32 s3, s87, 3
    v_add_u32 v12, s3, v10
    v_lshlrev_b32 v12, 3, v12
    s_and_b32 s3, s2, 7
    v_add_u32 v12, s3, v12
    v_lshlrev_b32 v12, 7, v12
    v_add_u32 v243, 6291456, v12
    v_and_b32 v12, 15, v2
    v_lshlrev_b32 v12, 21, v12
    buffer_load_dword v192, v12, s[56:59], 0 offen
    buffer_load_dword v193, v12, s[48:51], 0 offen
    buffer_load_dword v194, v12, s[52:55], 0 offen
    buffer_load_dword v195, v12, s[60:63], 0 offen
    s_waitcnt vmcnt(8)
    s_waitcnt lgkmcnt(0)
    s_barrier
    ds_read_b128 a[20:23], v164 offset:0
    ds_read_b64_tr_b16 a[0:1], v168 offset:0
    ds_read_b64_tr_b16 a[2:3], v168 offset:2048
    ds_read_b64_tr_b16 a[4:5], v169 offset:0
    ds_read_b64_tr_b16 a[6:7], v169 offset:2048
    ds_read_b64_tr_b16 a[8:9], v170 offset:0
    ds_read_b64_tr_b16 a[10:11], v170 offset:2048
    ds_read_b64_tr_b16 a[12:13], v171 offset:0
    ds_read_b64_tr_b16 a[14:15], v171 offset:2048
    ds_read_b128 a[16:19], v160 offset:0
    s_waitcnt lgkmcnt(7)
    v_mfma_f32_32x32x16_bf16 v[64:79], a[0:3], a[20:23], 0
    ds_read_b128 a[44:47], v165 offset:0
    ds_read_b64_tr_b16 a[24:25], v168 offset:8192
    ds_read_b64_tr_b16 a[26:27], v168 offset:10240
    s_add_u32 m0, s72, 114688
    s_lshl_b32 s78, s74, 7
    s_add_u32 s74, s74, 1
    s_cmp_eq_u32 s74, 7
    s_cselect_b32 s74, 0, s74
    buffer_load_dwordx4 v172, s[36:39], s78 offen lds
    s_waitcnt lgkmcnt(8)
    v_mfma_f32_32x32x16_bf16 v[80:95], a[4:7], a[20:23], 0
    ds_read_b64_tr_b16 a[28:29], v169 offset:8192
    ds_read_b64_tr_b16 a[30:31], v169 offset:10240
    ds_read_b64_tr_b16 a[32:33], v170 offset:8192
    buffer_load_dwordx4 v173, s[36:39], s78 offen offset:1024 lds
    s_waitcnt lgkmcnt(9)
    v_mfma_f32_32x32x16_bf16 v[96:111], a[8:11], a[20:23], 0
    ds_read_b64_tr_b16 a[34:35], v170 offset:10240
    ds_read_b64_tr_b16 a[36:37], v171 offset:8192
    ds_read_b64_tr_b16 a[38:39], v171 offset:10240
    s_add_u32 m0, s72, 114688
    s_nop 0
    buffer_load_dwordx4 v174, s[36:39], s78 offen offset:2048 lds
    s_waitcnt lgkmcnt(10)
    v_mfma_f32_32x32x16_bf16 v[112:127], a[12:15], a[20:23], 0
    ds_read_b128 a[40:43], v161 offset:0
    buffer_load_dwordx4 v175, s[36:39], s78 offen offset:3072 lds
    s_waitcnt lgkmcnt(10)
    v_mfma_f32_32x32x16_bf16 v[0:15], a[0:3], a[16:19], 0
    s_add_u32 m0, s72, 32768
    s_lshl_b32 s75, s73, 19
    buffer_load_dwordx4 v176, s[40:43], s75 offen lds
    v_mfma_f32_32x32x16_bf16 v[16:31], a[4:7], a[16:19], 0
    buffer_load_dwordx4 v177, s[40:43], s75 offen offset:1024 lds
    v_mfma_f32_32x32x16_bf16 v[32:47], a[8:11], a[16:19], 0
    buffer_load_dwordx4 v178, s[40:43], s75 offen offset:2048 lds
    v_mfma_f32_32x32x16_bf16 v[48:63], a[12:15], a[16:19], 0
    buffer_load_dwordx4 v179, s[40:43], s75 offen offset:3072 lds
    s_waitcnt vmcnt(12)
    s_waitcnt lgkmcnt(0)
    s_barrier
    v_mfma_f32_32x32x16_bf16 v[64:79], a[24:27], a[44:47], v[64:79]
    ds_read_b128 a[20:23], v166 offset:0
    ds_read_b64_tr_b16 a[0:1], v168 offset:16384
    ds_read_b64_tr_b16 a[2:3], v168 offset:18432
    v_mfma_f32_32x32x16_bf16 v[80:95], a[28:31], a[44:47], v[80:95]
    ds_read_b64_tr_b16 a[4:5], v169 offset:16384
    ds_read_b64_tr_b16 a[6:7], v169 offset:18432
    ds_read_b64_tr_b16 a[8:9], v170 offset:16384
    v_mfma_f32_32x32x16_bf16 v[96:111], a[32:35], a[44:47], v[96:111]
    ds_read_b64_tr_b16 a[10:11], v170 offset:18432
    ds_read_b64_tr_b16 a[12:13], v171 offset:16384
    ds_read_b64_tr_b16 a[14:15], v171 offset:18432
    v_mfma_f32_32x32x16_bf16 v[112:127], a[36:39], a[44:47], v[112:127]
    ds_read_b128 a[16:19], v162 offset:0
    v_mfma_f32_32x32x16_bf16 v[0:15], a[24:27], a[40:43], v[0:15]
    s_add_u32 m0, s72, 49152
    s_lshl_b32 s76, s73, 19
    s_add_u32 s76, s76, 262144
    s_add_u32 s73, s73, 1
    s_cmp_eq_u32 s73, 7
    s_cselect_b32 s73, 0, s73
    buffer_load_dwordx4 v176, s[40:43], s76 offen lds
    v_mfma_f32_32x32x16_bf16 v[16:31], a[28:31], a[40:43], v[16:31]
    buffer_load_dwordx4 v177, s[40:43], s76 offen offset:1024 lds
    v_mfma_f32_32x32x16_bf16 v[32:47], a[32:35], a[40:43], v[32:47]
    buffer_load_dwordx4 v178, s[40:43], s76 offen offset:2048 lds
    v_mfma_f32_32x32x16_bf16 v[48:63], a[36:39], a[40:43], v[48:63]
    buffer_load_dwordx4 v179, s[40:43], s76 offen offset:3072 lds
    s_waitcnt lgkmcnt(7)
    v_mfma_f32_32x32x16_bf16 v[64:79], a[0:3], a[20:23], v[64:79]
    ds_read_b128 a[44:47], v167 offset:0
    ds_read_b64_tr_b16 a[24:25], v168 offset:24576
    ds_read_b64_tr_b16 a[26:27], v168 offset:26624
    s_waitcnt lgkmcnt(8)
    v_mfma_f32_32x32x16_bf16 v[80:95], a[4:7], a[20:23], v[80:95]
    ds_read_b64_tr_b16 a[28:29], v169 offset:24576
    ds_read_b64_tr_b16 a[30:31], v169 offset:26624
    ds_read_b64_tr_b16 a[32:33], v170 offset:24576
    s_waitcnt lgkmcnt(9)
    v_mfma_f32_32x32x16_bf16 v[96:111], a[8:11], a[20:23], v[96:111]
    ds_read_b64_tr_b16 a[34:35], v170 offset:26624
    ds_read_b64_tr_b16 a[36:37], v171 offset:24576
    ds_read_b64_tr_b16 a[38:39], v171 offset:26624
    s_waitcnt lgkmcnt(10)
    v_mfma_f32_32x32x16_bf16 v[112:127], a[12:15], a[20:23], v[112:127]
    ds_read_b128 a[40:43], v163 offset:0
    s_waitcnt lgkmcnt(10)
    v_mfma_f32_32x32x16_bf16 v[0:15], a[0:3], a[16:19], v[0:15]
    s_add_u32 m0, s72, 65536
    s_lshl_b32 s75, s73, 19
    buffer_load_dwordx4 v176, s[40:43], s75 offen lds
    v_mfma_f32_32x32x16_bf16 v[16:31], a[4:7], a[16:19], v[16:31]
    buffer_load_dwordx4 v177, s[40:43], s75 offen offset:1024 lds
    v_mfma_f32_32x32x16_bf16 v[32:47], a[8:11], a[16:19], v[32:47]
    buffer_load_dwordx4 v178, s[40:43], s75 offen offset:2048 lds
    v_mfma_f32_32x32x16_bf16 v[48:63], a[12:15], a[16:19], v[48:63]
    buffer_load_dwordx4 v179, s[40:43], s75 offen offset:3072 lds
    s_waitcnt vmcnt(8)
    s_waitcnt lgkmcnt(0)
    s_barrier
    v_mfma_f32_32x32x16_bf16 v[64:79], a[24:27], a[44:47], v[64:79]
    ds_read_b128 a[20:23], v164 offset:16384
    ds_read_b64_tr_b16 a[0:1], v168 offset:32768
    ds_read_b64_tr_b16 a[2:3], v168 offset:34816
    v_mfma_f32_32x32x16_bf16 v[80:95], a[28:31], a[44:47], v[80:95]
    ds_read_b64_tr_b16 a[4:5], v169 offset:32768
    ds_read_b64_tr_b16 a[6:7], v169 offset:34816
    ds_read_b64_tr_b16 a[8:9], v170 offset:32768
    v_mfma_f32_32x32x16_bf16 v[96:111], a[32:35], a[44:47], v[96:111]
    ds_read_b64_tr_b16 a[10:11], v170 offset:34816
    ds_read_b64_tr_b16 a[12:13], v171 offset:32768
    ds_read_b64_tr_b16 a[14:15], v171 offset:34816
    v_mfma_f32_32x32x16_bf16 v[112:127], a[36:39], a[44:47], v[112:127]
    ds_read_b128 a[16:19], v160 offset:16384
    buffer_load_dwordx2 v[250:251], v242, s[64:67], 0 offen sc1
    v_mfma_f32_32x32x16_bf16 v[0:15], a[24:27], a[40:43], v[0:15]
    s_add_u32 m0, s72, 131072
    s_lshl_b32 s77, s74, 7
    s_add_u32 s74, s74, 1
    s_cmp_eq_u32 s74, 7
    s_cselect_b32 s74, 0, s74
    buffer_load_dwordx4 v172, s[36:39], s77 offen lds
    v_mfma_f32_32x32x16_bf16 v[16:31], a[28:31], a[40:43], v[16:31]
    buffer_load_dwordx4 v173, s[36:39], s77 offen offset:1024 lds
    v_mfma_f32_32x32x16_bf16 v[32:47], a[32:35], a[40:43], v[32:47]
    s_add_u32 m0, s72, 131072
    s_nop 0
    buffer_load_dwordx4 v174, s[36:39], s77 offen offset:2048 lds
    v_mfma_f32_32x32x16_bf16 v[48:63], a[36:39], a[40:43], v[48:63]
    buffer_load_dwordx4 v175, s[36:39], s77 offen offset:3072 lds
    s_waitcnt lgkmcnt(7)
    v_mfma_f32_32x32x16_bf16 v[64:79], a[0:3], a[20:23], v[64:79]
    ds_read_b128 a[44:47], v165 offset:16384
    ds_read_b64_tr_b16 a[24:25], v168 offset:40960
    ds_read_b64_tr_b16 a[26:27], v168 offset:43008
    s_waitcnt lgkmcnt(8)
    v_mfma_f32_32x32x16_bf16 v[80:95], a[4:7], a[20:23], v[80:95]
    ds_read_b64_tr_b16 a[28:29], v169 offset:40960
    ds_read_b64_tr_b16 a[30:31], v169 offset:43008
    ds_read_b64_tr_b16 a[32:33], v170 offset:40960
    s_waitcnt lgkmcnt(9)
    v_mfma_f32_32x32x16_bf16 v[96:111], a[8:11], a[20:23], v[96:111]
    ds_read_b64_tr_b16 a[34:35], v170 offset:43008
    ds_read_b64_tr_b16 a[36:37], v171 offset:40960
    ds_read_b64_tr_b16 a[38:39], v171 offset:43008
    s_waitcnt lgkmcnt(10)
    v_mfma_f32_32x32x16_bf16 v[112:127], a[12:15], a[20:23], v[112:127]
    ds_read_b128 a[40:43], v161 offset:16384
    s_waitcnt lgkmcnt(10)
    v_mfma_f32_32x32x16_bf16 v[0:15], a[0:3], a[16:19], v[0:15]
    s_add_u32 m0, s72, 81920
    s_lshl_b32 s76, s73, 19
    s_add_u32 s76, s76, 262144
    s_add_u32 s73, s73, 1
    s_cmp_eq_u32 s73, 7
    s_cselect_b32 s73, 0, s73
    buffer_load_dwordx4 v176, s[40:43], s76 offen lds
    v_mfma_f32_32x32x16_bf16 v[16:31], a[4:7], a[16:19], v[16:31]
    buffer_load_dwordx4 v177, s[40:43], s76 offen offset:1024 lds
    v_mfma_f32_32x32x16_bf16 v[32:47], a[8:11], a[16:19], v[32:47]
    buffer_load_dwordx4 v178, s[40:43], s76 offen offset:2048 lds
    v_mfma_f32_32x32x16_bf16 v[48:63], a[12:15], a[16:19], v[48:63]
    buffer_load_dwordx4 v179, s[40:43], s76 offen offset:3072 lds
    v_add_u32 v168, 49152, v168
    v_add_u32 v169, 49152, v169
    v_add_u32 v170, 49152, v170
    v_add_u32 v171, 49152, v171
    s_waitcnt vmcnt(13)
    s_waitcnt lgkmcnt(0)
    s_barrier
    v_mfma_f32_32x32x16_bf16 v[64:79], a[24:27], a[44:47], v[64:79]
    ds_read_b128 a[20:23], v166 offset:16384
    ds_read_b64_tr_b16 a[0:1], v168 offset:0
    ds_read_b64_tr_b16 a[2:3], v168 offset:2048
    v_mfma_f32_32x32x16_bf16 v[80:95], a[28:31], a[44:47], v[80:95]
    ds_read_b64_tr_b16 a[4:5], v169 offset:0
    ds_read_b64_tr_b16 a[6:7], v169 offset:2048
    ds_read_b64_tr_b16 a[8:9], v170 offset:0
    s_add_u32 m0, s72, 147456
    s_xor_b32 s91, s21, 0
    s_add_u32 s91, s91, s80
    buffer_load_dwordx4 v216, s[44:47], s91 offen lds
    v_mfma_f32_32x32x16_bf16 v[96:111], a[32:35], a[44:47], v[96:111]
    ds_read_b64_tr_b16 a[10:11], v170 offset:2048
    ds_read_b64_tr_b16 a[12:13], v171 offset:0
    ds_read_b64_tr_b16 a[14:15], v171 offset:2048
    buffer_load_dwordx4 v217, s[44:47], s91 offen offset:1024 lds
    v_mfma_f32_32x32x16_bf16 v[112:127], a[36:39], a[44:47], v[112:127]
    ds_read_b128 a[16:19], v162 offset:16384
    buffer_load_dwordx4 v218, s[44:47], s91 offen offset:2048 lds
    v_mfma_f32_32x32x16_bf16 v[0:15], a[24:27], a[40:43], v[0:15]
    buffer_load_dwordx4 v219, s[44:47], s91 offen offset:3072 lds
    v_mfma_f32_32x32x16_bf16 v[16:31], a[28:31], a[40:43], v[16:31]
    s_add_u32 m0, s72, 0
    s_lshl_b32 s75, s73, 19
    buffer_load_dwordx4 v176, s[40:43], s75 offen lds
    v_mfma_f32_32x32x16_bf16 v[32:47], a[32:35], a[40:43], v[32:47]
    buffer_load_dwordx4 v177, s[40:43], s75 offen offset:1024 lds
    v_mfma_f32_32x32x16_bf16 v[48:63], a[36:39], a[40:43], v[48:63]
    buffer_load_dwordx4 v178, s[40:43], s75 offen offset:2048 lds
    s_waitcnt lgkmcnt(7)
    v_mfma_f32_32x32x16_bf16 v[64:79], a[0:3], a[20:23], v[64:79]
    ds_read_b128 a[44:47], v167 offset:16384
    ds_read_b64_tr_b16 a[24:25], v168 offset:8192
    ds_read_b64_tr_b16 a[26:27], v168 offset:10240
    s_waitcnt lgkmcnt(8)
    v_mfma_f32_32x32x16_bf16 v[80:95], a[4:7], a[20:23], v[80:95]
    ds_read_b64_tr_b16 a[28:29], v169 offset:8192
    ds_read_b64_tr_b16 a[30:31], v169 offset:10240
    ds_read_b64_tr_b16 a[32:33], v170 offset:8192
    buffer_load_dwordx4 v179, s[40:43], s75 offen offset:3072 lds
    s_waitcnt lgkmcnt(9)
    v_mfma_f32_32x32x16_bf16 v[96:111], a[8:11], a[20:23], v[96:111]
    ds_read_b64_tr_b16 a[34:35], v170 offset:10240
    ds_read_b64_tr_b16 a[36:37], v171 offset:8192
    ds_read_b64_tr_b16 a[38:39], v171 offset:10240
    s_add_u32 m0, s72, 98304
    s_lshl_b32 s78, s74, 7
    s_add_u32 s74, s74, 1
    s_cmp_eq_u32 s74, 7
    s_cselect_b32 s74, 0, s74
    buffer_load_dwordx4 v172, s[36:39], s78 offen lds
    s_waitcnt lgkmcnt(10)
    v_mfma_f32_32x32x16_bf16 v[112:127], a[12:15], a[20:23], v[112:127]
    ds_read_b128 a[40:43], v163 offset:16384
    buffer_load_dwordx4 v173, s[36:39], s78 offen offset:1024 lds
    s_waitcnt lgkmcnt(10)
    v_mfma_f32_32x32x16_bf16 v[0:15], a[0:3], a[16:19], v[0:15]
    s_add_u32 m0, s72, 16384
    s_lshl_b32 s76, s73, 19
    s_add_u32 s76, s76, 262144
    s_add_u32 s73, s73, 1
    s_cmp_eq_u32 s73, 7
    s_cselect_b32 s73, 0, s73
    buffer_load_dwordx4 v176, s[40:43], s76 offen lds
    v_mfma_f32_32x32x16_bf16 v[16:31], a[4:7], a[16:19], v[16:31]
    buffer_load_dwordx4 v177, s[40:43], s76 offen offset:1024 lds
    v_mfma_f32_32x32x16_bf16 v[32:47], a[8:11], a[16:19], v[32:47]
    buffer_load_dwordx4 v178, s[40:43], s76 offen offset:2048 lds
    v_mfma_f32_32x32x16_bf16 v[48:63], a[12:15], a[16:19], v[48:63]
    buffer_load_dwordx4 v179, s[40:43], s76 offen offset:3072 lds
    s_waitcnt vmcnt(23)
    s_waitcnt vmcnt(18)
    s_waitcnt lgkmcnt(0)
    s_barrier
    v_mfma_f32_32x32x16_bf16 v[64:79], a[24:27], a[44:47], v[64:79]
    ds_read_b128 a[20:23], v164 offset:32768
    ds_read_b64_tr_b16 a[0:1], v168 offset:16384
    ds_read_b64_tr_b16 a[2:3], v168 offset:18432
    v_mfma_f32_32x32x16_bf16 v[80:95], a[28:31], a[44:47], v[80:95]
    ds_read_b64_tr_b16 a[4:5], v169 offset:16384
    ds_read_b64_tr_b16 a[6:7], v169 offset:18432
    ds_read_b64_tr_b16 a[8:9], v170 offset:16384
    v_mfma_f32_32x32x16_bf16 v[96:111], a[32:35], a[44:47], v[96:111]
    ds_read_b64_tr_b16 a[10:11], v170 offset:18432
    ds_read_b64_tr_b16 a[12:13], v171 offset:16384
    ds_read_b64_tr_b16 a[14:15], v171 offset:18432
    v_mfma_f32_32x32x16_bf16 v[112:127], a[36:39], a[44:47], v[112:127]
    ds_read_b128 a[16:19], v160 offset:32768
    s_add_u32 m0, s72, 98304
    s_nop 0
    buffer_load_dwordx4 v174, s[36:39], s78 offen offset:2048 lds
    v_mfma_f32_32x32x16_bf16 v[0:15], a[24:27], a[40:43], v[0:15]
    buffer_load_dwordx4 v175, s[36:39], s78 offen offset:3072 lds
    v_mfma_f32_32x32x16_bf16 v[16:31], a[28:31], a[40:43], v[16:31]
    s_add_u32 m0, s72, 32768
    s_lshl_b32 s75, s73, 19
    buffer_load_dwordx4 v176, s[40:43], s75 offen lds
    v_mfma_f32_32x32x16_bf16 v[32:47], a[32:35], a[40:43], v[32:47]
    buffer_load_dwordx4 v177, s[40:43], s75 offen offset:1024 lds
    v_mfma_f32_32x32x16_bf16 v[48:63], a[36:39], a[40:43], v[48:63]
    buffer_load_dwordx4 v178, s[40:43], s75 offen offset:2048 lds
    s_waitcnt lgkmcnt(7)
    v_mfma_f32_32x32x16_bf16 v[64:79], a[0:3], a[20:23], v[64:79]
    ds_read_b128 a[44:47], v165 offset:32768
    ds_read_b64_tr_b16 a[24:25], v168 offset:24576
    ds_read_b64_tr_b16 a[26:27], v168 offset:26624
    s_waitcnt lgkmcnt(8)
    v_mfma_f32_32x32x16_bf16 v[80:95], a[4:7], a[20:23], v[80:95]
    ds_read_b64_tr_b16 a[28:29], v169 offset:24576
    ds_read_b64_tr_b16 a[30:31], v169 offset:26624
    ds_read_b64_tr_b16 a[32:33], v170 offset:24576
    s_waitcnt lgkmcnt(9)
    v_mfma_f32_32x32x16_bf16 v[96:111], a[8:11], a[20:23], v[96:111]
    ds_read_b64_tr_b16 a[34:35], v170 offset:26624
    ds_read_b64_tr_b16 a[36:37], v171 offset:24576
    ds_read_b64_tr_b16 a[38:39], v171 offset:26624
    s_waitcnt lgkmcnt(10)
    v_mfma_f32_32x32x16_bf16 v[112:127], a[12:15], a[20:23], v[112:127]
    ds_read_b128 a[40:43], v161 offset:32768
    buffer_load_dwordx4 v179, s[40:43], s75 offen offset:3072 lds
    s_waitcnt lgkmcnt(10)
    v_mfma_f32_32x32x16_bf16 v[0:15], a[0:3], a[16:19], v[0:15]
    s_add_u32 m0, s72, 49152
    s_lshl_b32 s76, s73, 19
    s_add_u32 s76, s76, 262144
    s_add_u32 s73, s73, 1
    s_cmp_eq_u32 s73, 7
    s_cselect_b32 s73, 0, s73
    buffer_load_dwordx4 v176, s[40:43], s76 offen lds
    v_mfma_f32_32x32x16_bf16 v[16:31], a[4:7], a[16:19], v[16:31]
    buffer_load_dwordx4 v177, s[40:43], s76 offen offset:1024 lds
    v_mfma_f32_32x32x16_bf16 v[32:47], a[8:11], a[16:19], v[32:47]
    buffer_load_dwordx4 v178, s[40:43], s76 offen offset:2048 lds
    v_mfma_f32_32x32x16_bf16 v[48:63], a[12:15], a[16:19], v[48:63]
    buffer_load_dwordx4 v179, s[40:43], s76 offen offset:3072 lds
    s_waitcnt vmcnt(24)
    s_waitcnt lgkmcnt(0)
    s_barrier
    v_mfma_f32_32x32x16_bf16 v[64:79], a[24:27], a[44:47], v[64:79]
    ds_read_b128 a[20:23], v166 offset:32768
    ds_read_b64_tr_b16 a[0:1], v168 offset:32768
    ds_read_b64_tr_b16 a[2:3], v168 offset:34816
    v_mfma_f32_32x32x16_bf16 v[80:95], a[28:31], a[44:47], v[80:95]
    ds_read_b64_tr_b16 a[4:5], v169 offset:32768
    ds_read_b64_tr_b16 a[6:7], v169 offset:34816
    ds_read_b64_tr_b16 a[8:9], v170 offset:32768
    v_mfma_f32_32x32x16_bf16 v[96:111], a[32:35], a[44:47], v[96:111]
    ds_read_b64_tr_b16 a[10:11], v170 offset:34816
    ds_read_b64_tr_b16 a[12:13], v171 offset:32768
    ds_read_b64_tr_b16 a[14:15], v171 offset:34816
    v_mfma_f32_32x32x16_bf16 v[112:127], a[36:39], a[44:47], v[112:127]
    ds_read_b128 a[16:19], v162 offset:32768
    v_mfma_f32_32x32x16_bf16 v[0:15], a[24:27], a[40:43], v[0:15]
    s_add_u32 s91, s16, 16384
    buffer_store_dwordx4 v[200:203], v234, s[56:59], s91 offen offset:0 sc1
    v_mfma_f32_32x32x16_bf16 v[16:31], a[28:31], a[40:43], v[16:31]
    buffer_store_dwordx4 v[200:203], v234, s[56:59], s91 offen offset:1024 sc1
    v_mfma_f32_32x32x16_bf16 v[32:47], a[32:35], a[40:43], v[32:47]
    s_add_u32 m0, s72, 114688
    s_lshl_b32 s77, s74, 7
    s_add_u32 s74, s74, 1
    s_cmp_eq_u32 s74, 7
    s_cselect_b32 s74, 0, s74
    buffer_load_dwordx4 v172, s[36:39], s77 offen lds
    v_mfma_f32_32x32x16_bf16 v[48:63], a[36:39], a[40:43], v[48:63]
    buffer_load_dwordx4 v173, s[36:39], s77 offen offset:1024 lds
    s_waitcnt lgkmcnt(7)
    v_mfma_f32_32x32x16_bf16 v[64:79], a[0:3], a[20:23], v[64:79]
    ds_read_b128 a[44:47], v167 offset:32768
    ds_read_b64_tr_b16 a[24:25], v168 offset:40960
    ds_read_b64_tr_b16 a[26:27], v168 offset:43008
    s_waitcnt lgkmcnt(8)
    v_mfma_f32_32x32x16_bf16 v[80:95], a[4:7], a[20:23], v[80:95]
    ds_read_b64_tr_b16 a[28:29], v169 offset:40960
    ds_read_b64_tr_b16 a[30:31], v169 offset:43008
    ds_read_b64_tr_b16 a[32:33], v170 offset:40960
    s_waitcnt lgkmcnt(9)
    v_mfma_f32_32x32x16_bf16 v[96:111], a[8:11], a[20:23], v[96:111]
    ds_read_b64_tr_b16 a[34:35], v170 offset:43008
    ds_read_b64_tr_b16 a[36:37], v171 offset:40960
    ds_read_b64_tr_b16 a[38:39], v171 offset:43008
    s_waitcnt lgkmcnt(10)
    v_mfma_f32_32x32x16_bf16 v[112:127], a[12:15], a[20:23], v[112:127]
    ds_read_b128 a[40:43], v163 offset:32768
    s_waitcnt lgkmcnt(10)
    v_mfma_f32_32x32x16_bf16 v[0:15], a[0:3], a[16:19], v[0:15]
    s_add_u32 m0, s72, 65536
    s_lshl_b32 s75, s73, 19
    buffer_load_dwordx4 v176, s[40:43], s75 offen lds
    v_mfma_f32_32x32x16_bf16 v[16:31], a[4:7], a[16:19], v[16:31]
    buffer_load_dwordx4 v177, s[40:43], s75 offen offset:1024 lds
    v_mfma_f32_32x32x16_bf16 v[32:47], a[8:11], a[16:19], v[32:47]
    buffer_load_dwordx4 v178, s[40:43], s75 offen offset:2048 lds
    v_mfma_f32_32x32x16_bf16 v[48:63], a[12:15], a[16:19], v[48:63]
    buffer_load_dwordx4 v179, s[40:43], s75 offen offset:3072 lds
    s_waitcnt vmcnt(28)
    ds_read_b128 a[80:83], v180
    ds_read_b128 a[84:87], v181
    ds_read_b128 a[88:91], v182
    ds_read_b128 a[92:95], v183
    v_subrev_u32 v168, 49152, v168
    v_subrev_u32 v169, 49152, v169
    v_subrev_u32 v170, 49152, v170
    v_subrev_u32 v171, 49152, v171
    s_waitcnt vmcnt(24)
    s_waitcnt vmcnt(16)
    s_waitcnt lgkmcnt(0)
    s_barrier
    v_min_u32 v248, v250, v251
    v_cmp_ne_u32 vcc, 0, v248
    s_nop 3
    s_cmp_eq_u64 vcc, -1
    s_cbranch_scc0 L_slow0
L_back0:
    v_mfma_f32_32x32x16_bf16 v[64:79], a[24:27], a[44:47], v[64:79]
    ds_read_b128 a[20:23], v164 offset:0
    ds_read_b64_tr_b16 a[0:1], v168 offset:0
    ds_read_b64_tr_b16 a[2:3], v168 offset:2048
    v_mfma_f32_32x32x16_bf16 v[80:95], a[28:31], a[44:47], v[80:95]
    ds_read_b64_tr_b16 a[4:5], v169 offset:0
    ds_read_b64_tr_b16 a[6:7], v169 offset:2048
    ds_read_b64_tr_b16 a[8:9], v170 offset:0
    v_mfma_f32_32x32x16_bf16 v[96:111], a[32:35], a[44:47], v[96:111]
    ds_read_b64_tr_b16 a[10:11], v170 offset:2048
    ds_read_b64_tr_b16 a[12:13], v171 offset:0
    ds_read_b64_tr_b16 a[14:15], v171 offset:2048
    v_mfma_f32_32x32x16_bf16 v[112:127], a[36:39], a[44:47], v[112:127]
    ds_read_b128 a[16:19], v160 offset:0
    s_add_u32 m0, s72, 147456
    s_xor_b32 s91, s21, 128
    s_add_u32 s91, s91, s80
    buffer_load_dwordx4 v216, s[44:47], s91 offen lds
    v_mfma_f32_32x32x16_bf16 v[0:15], a[24:27], a[40:43], v[0:15]
    buffer_load_dwordx4 v217, s[44:47], s91 offen offset:1024 lds
    v_mfma_f32_32x32x16_bf16 v[16:31], a[28:31], a[40:43], v[16:31]
    buffer_load_dwordx4 v218, s[44:47], s91 offen offset:2048 lds
    v_mfma_f32_32x32x16_bf16 v[32:47], a[32:35], a[40:43], v[32:47]
    buffer_load_dwordx4 v219, s[44:47], s91 offen offset:3072 lds
    v_mfma_f32_32x32x16_bf16 v[48:63], a[36:39], a[40:43], v[48:63]
    s_add_u32 m0, s72, 114688
    s_nop 0
    buffer_load_dwordx4 v174, s[36:39], s77 offen offset:2048 lds
    s_waitcnt lgkmcnt(7)
    v_mfma_f32_32x32x16_bf16 v[64:79], a[0:3], a[20:23], v[64:79]
    ds_read_b128 a[44:47], v165 offset:0
    ds_read_b64_tr_b16 a[24:25], v168 offset:8192
    ds_read_b64_tr_b16 a[26:27], v168 offset:10240
    s_waitcnt lgkmcnt(8)
    v_mfma_f32_32x32x16_bf16 v[80:95], a[4:7], a[20:23], v[80:95]
    ds_read_b64_tr_b16 a[28:29], v169 offset:8192
    ds_read_b64_tr_b16 a[30:31], v169 offset:10240
    ds_read_b64_tr_b16 a[32:33], v170 offset:8192
    s_waitcnt lgkmcnt(9)
    v_mfma_f32_32x32x16_bf16 v[96:111], a[8:11], a[20:23], v[96:111]
    ds_read_b64_tr_b16 a[34:35], v170 offset:10240
    ds_read_b64_tr_b16 a[36:37], v171 offset:8192
    ds_read_b64_tr_b16 a[38:39], v171 offset:10240
    s_waitcnt lgkmcnt(10)
    v_mfma_f32_32x32x16_bf16 v[112:127], a[12:15], a[20:23], v[112:127]
    ds_read_b128 a[40:43], v161 offset:0
    buffer_load_dwordx4 v175, s[36:39], s77 offen offset:3072 lds
    s_waitcnt lgkmcnt(10)
    v_mfma_f32_32x32x16_bf16 v[0:15], a[0:3], a[16:19], v[0:15]
    s_add_u32 m0, s72, 81920
    s_lshl_b32 s76, s73, 19
    s_add_u32 s76, s76, 262144
    s_add_u32 s73, s73, 1
    s_cmp_eq_u32 s73, 7
    s_cselect_b32 s73, 0, s73
    buffer_load_dwordx4 v176, s[40:43], s76 offen lds
    v_mfma_f32_32x32x16_bf16 v[16:31], a[4:7], a[16:19], v[16:31]
    buffer_load_dwordx4 v177, s[40:43], s76 offen offset:1024 lds
    v_mfma_f32_32x32x16_bf16 v[32:47], a[8:11], a[16:19], v[32:47]
    buffer_load_dwordx4 v178, s[40:43], s76 offen offset:2048 lds
    v_mfma_f32_32x32x16_bf16 v[48:63], a[12:15], a[16:19], v[48:63]
    buffer_load_dwordx4 v179, s[40:43], s76 offen offset:3072 lds
    s_waitcnt lgkmcnt(0)
    s_barrier
    v_mfma_f32_32x32x16_bf16 v[64:79], a[24:27], a[44:47], v[64:79]
    ds_read_b128 a[20:23], v166 offset:0
    ds_read_b64_tr_b16 a[0:1], v168 offset:16384
    ds_read_b64_tr_b16 a[2:3], v168 offset:18432
    v_mfma_f32_32x32x16_bf16 v[80:95], a[28:31], a[44:47], v[80:95]
    ds_read_b64_tr_b16 a[4:5], v169 offset:16384
    ds_read_b64_tr_b16 a[6:7], v169 offset:18432
    ds_read_b64_tr_b16 a[8:9], v170 offset:16384
    v_mfma_f32_32x32x16_bf16 v[96:111], a[32:35], a[44:47], v[96:111]
    ds_read_b64_tr_b16 a[10:11], v170 offset:18432
    ds_read_b64_tr_b16 a[12:13], v171 offset:16384
    ds_read_b64_tr_b16 a[14:15], v171 offset:18432
    v_mfma_f32_32x32x16_bf16 v[112:127], a[36:39], a[44:47], v[112:127]
    ds_read_b128 a[16:19], v162 offset:0
    v_mfma_f32_32x32x16_bf16 v[0:15], a[24:27], a[40:43], v[0:15]
    s_add_u32 m0, s72, 131072
    s_lshl_b32 s78, s74, 7
    s_add_u32 s74, s74, 1
    s_cmp_eq_u32 s74, 7
    s_cselect_b32 s74, 0, s74
    buffer_load_dwordx4 v172, s[36:39], s78 offen lds
    v_mfma_f32_32x32x16_bf16 v[16:31], a[28:31], a[40:43], v[16:31]
    buffer_load_dwordx4 v173, s[36:39], s78 offen offset:1024 lds
    v_mfma_f32_32x32x16_bf16 v[32:47], a[32:35], a[40:43], v[32:47]
    s_add_u32 m0, s72, 0
    s_lshl_b32 s75, s73, 19
    buffer_load_dwordx4 v176, s[40:43], s75 offen lds
    v_mfma_f32_32x32x16_bf16 v[48:63], a[36:39], a[40:43], v[48:63]
    s_waitcnt lgkmcnt(7)
    v_mfma_f32_32x32x16_bf16 v[64:79], a[0:3], a[20:23], v[64:79]
    ds_read_b128 a[44:47], v167 offset:0
    ds_read_b64_tr_b16 a[24:25], v168 offset:24576
    ds_read_b64_tr_b16 a[26:27], v168 offset:26624
    s_waitcnt lgkmcnt(8)
    v_mfma_f32_32x32x16_bf16 v[80:95], a[4:7], a[20:23], v[80:95]
    ds_read_b64_tr_b16 a[28:29], v169 offset:24576
    ds_read_b64_tr_b16 a[30:31], v169 offset:26624
    ds_read_b64_tr_b16 a[32:33], v170 offset:24576
    s_waitcnt lgkmcnt(9)
    v_mfma_f32_32x32x16_bf16 v[96:111], a[8:11], a[20:23], v[96:111]
    ds_read_b64_tr_b16 a[34:35], v170 offset:26624
    ds_read_b64_tr_b16 a[36:37], v171 offset:24576
    ds_read_b64_tr_b16 a[38:39], v171 offset:26624
    s_waitcnt lgkmcnt(10)
    v_mfma_f32_32x32x16_bf16 v[112:127], a[12:15], a[20:23], v[112:127]
    ds_read_b128 a[40:43], v163 offset:0
    s_waitcnt lgkmcnt(10)
    v_mfma_f32_32x32x16_bf16 v[0:15], a[0:3], a[16:19], v[0:15]
    buffer_load_dwordx4 v177, s[40:43], s75 offen offset:1024 lds
    v_mfma_f32_32x32x16_bf16 v[16:31], a[4:7], a[16:19], v[16:31]
    buffer_load_dwordx4 v178, s[40:43], s75 offen offset:2048 lds
    v_mfma_f32_32x32x16_bf16 v[32:47], a[8:11], a[16:19], v[32:47]
    buffer_load_dwordx4 v179, s[40:43], s75 offen offset:3072 lds
    v_mfma_f32_32x32x16_bf16 v[48:63], a[12:15], a[16:19], v[48:63]
    s_waitcnt vmcnt(12)
    ds_read_b128 a[96:99], v180
    ds_read_b128 a[100:103], v181
    ds_read_b128 a[104:107], v182
    ds_read_b128 a[108:111], v183
    s_waitcnt vmcnt(10)
    s_waitcnt lgkmcnt(0)
    s_barrier
    s_mov_b64 exec, 1
    buffer_store_dwordx2 v[250:251], v242, s[56:59], s17 offen offset:64 sc1
    s_mov_b64 exec, -1
    v_mfma_f32_32x32x16_bf16 v[64:79], a[24:27], a[44:47], v[64:79]
    ds_read_b128 a[20:23], v164 offset:16384
    ds_read_b64_tr_b16 a[0:1], v168 offset:32768
    ds_read_b64_tr_b16 a[2:3], v168 offset:34816
    v_mfma_f32_32x32x16_bf16 v[80:95], a[28:31], a[44:47], v[80:95]
    ds_read_b64_tr_b16 a[4:5], v169 offset:32768
    ds_read_b64_tr_b16 a[6:7], v169 offset:34816
    ds_read_b64_tr_b16 a[8:9], v170 offset:32768
    v_mfma_f32_32x32x16_bf16 v[96:111], a[32:35], a[44:47], v[96:111]
    ds_read_b64_tr_b16 a[10:11], v170 offset:34816
    ds_read_b64_tr_b16 a[12:13], v171 offset:32768
    ds_read_b64_tr_b16 a[14:15], v171 offset:34816
    s_add_u32 m0, s72, 147456
    s_xor_b32 s91, s21, 0
    s_add_u32 s91, s91, s79
    buffer_load_dwordx4 v216, s[44:47], s91 offen lds
    v_mfma_f32_32x32x16_bf16 v[112:127], a[36:39], a[44:47], v[112:127]
    ds_read_b128 a[16:19], v160 offset:16384
    buffer_load_dwordx4 v217, s[44:47], s91 offen offset:1024 lds
    v_mfma_f32_32x32x16_bf16 v[0:15], a[24:27], a[40:43], v[0:15]
    buffer_load_dwordx4 v218, s[44:47], s91 offen offset:2048 lds
    v_mfma_f32_32x32x16_bf16 v[16:31], a[28:31], a[40:43], v[16:31]
    buffer_load_dwordx4 v219, s[44:47], s91 offen offset:3072 lds
    v_mfma_f32_32x32x16_bf16 v[32:47], a[32:35], a[40:43], v[32:47]
    s_add_u32 m0, s72, 131072
    s_nop 0
    buffer_load_dwordx4 v174, s[36:39], s78 offen offset:2048 lds
    v_mfma_f32_32x32x16_bf16 v[48:63], a[36:39], a[40:43], v[48:63]
    buffer_load_dwordx4 v175, s[36:39], s78 offen offset:3072 lds
    s_waitcnt lgkmcnt(7)
    v_mfma_f32_32x32x16_bf16 v[64:79], a[0:3], a[20:23], v[64:79]
    ds_read_b128 a[44:47], v165 offset:16384
    ds_read_b64_tr_b16 a[24:25], v168 offset:40960
    ds_read_b64_tr_b16 a[26:27], v168 offset:43008
    s_waitcnt lgkmcnt(8)
    v_mfma_f32_32x32x16_bf16 v[80:95], a[4:7], a[20:23], v[80:95]
    ds_read_b64_tr_b16 a[28:29], v169 offset:40960
    ds_read_b64_tr_b16 a[30:31], v169 offset:43008
    ds_read_b64_tr_b16 a[32:33], v170 offset:40960
    s_waitcnt lgkmcnt(9)
    v_mfma_f32_32x32x16_bf16 v[96:111], a[8:11], a[20:23], v[96:111]
    ds_read_b64_tr_b16 a[34:35], v170 offset:43008
    ds_read_b64_tr_b16 a[36:37], v171 offset:40960
    ds_read_b64_tr_b16 a[38:39], v171 offset:43008
    s_add_u32 m0, s72, 16384
    s_lshl_b32 s76, s73, 19
    s_add_u32 s76, s76, 262144
    s_add_u32 s73, s73, 1
    s_cmp_eq_u32 s73, 7
    s_cselect_b32 s73, 0, s73
    buffer_load_dwordx4 v176, s[40:43], s76 offen lds
    s_waitcnt lgkmcnt(10)
    v_mfma_f32_32x32x16_bf16 v[112:127], a[12:15], a[20:23], v[112:127]
    ds_read_b128 a[40:43], v161 offset:16384
    buffer_load_dwordx4 v177, s[40:43], s76 offen offset:1024 lds
    s_waitcnt lgkmcnt(10)
    v_mfma_f32_32x32x16_bf16 v[0:15], a[0:3], a[16:19], v[0:15]
    buffer_load_dwordx4 v178, s[40:43], s76 offen offset:2048 lds
    v_mfma_f32_32x32x16_bf16 v[16:31], a[4:7], a[16:19], v[16:31]
    buffer_load_dwordx4 v179, s[40:43], s76 offen offset:3072 lds
    v_mfma_f32_32x32x16_bf16 v[32:47], a[8:11], a[16:19], v[32:47]
    s_add_u32 m0, s72, 98304
    s_lshl_b32 s77, s74, 7
    s_add_u32 s74, s74, 1
    s_cmp_eq_u32 s74, 7
    s_cselect_b32 s74, 0, s74
    buffer_load_dwordx4 v172, s[36:39], s77 offen lds
    v_mfma_f32_32x32x16_bf16 v[48:63], a[12:15], a[16:19], v[48:63]
    buffer_load_dwordx4 v173, s[36:39], s77 offen offset:1024 lds
    v_add_u32 v168, 49152, v168
    v_add_u32 v169, 49152, v169
    v_add_u32 v170, 49152, v170
    v_add_u32 v171, 49152, v171
    s_waitcnt lgkmcnt(0)
    s_barrier
    v_mfma_f32_32x32x16_bf16 v[64:79], a[24:27], a[44:47], v[64:79]
    ds_read_b128 a[20:23], v166 offset:16384
    ds_read_b64_tr_b16 a[0:1], v168 offset:0
    ds_read_b64_tr_b16 a[2:3], v168 offset:2048
    v_mfma_f32_32x32x16_bf16 v[80:95], a[28:31], a[44:47], v[80:95]
    ds_read_b64_tr_b16 a[4:5], v169 offset:0
    ds_read_b64_tr_b16 a[6:7], v169 offset:2048
    ds_read_b64_tr_b16 a[8:9], v170 offset:0
    v_mfma_f32_32x32x16_bf16 v[96:111], a[32:35], a[44:47], v[96:111]
    ds_read_b64_tr_b16 a[10:11], v170 offset:2048
    ds_read_b64_tr_b16 a[12:13], v171 offset:0
    ds_read_b64_tr_b16 a[14:15], v171 offset:2048
    v_mfma_f32_32x32x16_bf16 v[112:127], a[36:39], a[44:47], v[112:127]
    ds_read_b128 a[16:19], v162 offset:16384
    v_mfma_f32_32x32x16_bf16 v[0:15], a[24:27], a[40:43], v[0:15]
    s_add_u32 m0, s72, 98304
    s_nop 0
    buffer_load_dwordx4 v174, s[36:39], s77 offen offset:2048 lds
    v_mfma_f32_32x32x16_bf16 v[16:31], a[28:31], a[40:43], v[16:31]
    buffer_load_dwordx4 v175, s[36:39], s77 offen offset:3072 lds
    v_mfma_f32_32x32x16_bf16 v[32:47], a[32:35], a[40:43], v[32:47]
    s_add_u32 m0, s72, 32768
    s_add_u32 s75, s96, 0
    s_and_b32 s75, s75, 3
    s_mul_i32 s75, s75, 57344
    buffer_load_dwordx4 v230, s[52:55], s75 offen lds
    v_mfma_f32_32x32x16_bf16 v[48:63], a[36:39], a[40:43], v[48:63]
    s_waitcnt lgkmcnt(7)
    v_mfma_f32_32x32x16_bf16 v[64:79], a[0:3], a[20:23], v[64:79]
    ds_read_b128 a[44:47], v167 offset:16384
    ds_read_b64_tr_b16 a[24:25], v168 offset:8192
    ds_read_b64_tr_b16 a[26:27], v168 offset:10240
    s_waitcnt lgkmcnt(8)
    v_mfma_f32_32x32x16_bf16 v[80:95], a[4:7], a[20:23], v[80:95]
    ds_read_b64_tr_b16 a[28:29], v169 offset:8192
    ds_read_b64_tr_b16 a[30:31], v169 offset:10240
    ds_read_b64_tr_b16 a[32:33], v170 offset:8192
    s_waitcnt lgkmcnt(9)
    v_mfma_f32_32x32x16_bf16 v[96:111], a[8:11], a[20:23], v[96:111]
    ds_read_b64_tr_b16 a[34:35], v170 offset:10240
    ds_read_b64_tr_b16 a[36:37], v171 offset:8192
    ds_read_b64_tr_b16 a[38:39], v171 offset:10240
    s_waitcnt lgkmcnt(10)
    v_mfma_f32_32x32x16_bf16 v[112:127], a[12:15], a[20:23], v[112:127]
    ds_read_b128 a[40:43], v163 offset:16384
    s_waitcnt lgkmcnt(10)
    v_mfma_f32_32x32x16_bf16 v[0:15], a[0:3], a[16:19], v[0:15]
    buffer_load_dwordx4 v231, s[52:55], s75 offen offset:1024 lds
    v_mfma_f32_32x32x16_bf16 v[16:31], a[4:7], a[16:19], v[16:31]
    buffer_load_dwordx4 v232, s[52:55], s75 offen offset:2048 lds
    v_mfma_f32_32x32x16_bf16 v[32:47], a[8:11], a[16:19], v[32:47]
    buffer_load_dwordx4 v233, s[52:55], s75 offen offset:3072 lds
    v_mfma_f32_32x32x16_bf16 v[48:63], a[12:15], a[16:19], v[48:63]
    s_waitcnt vmcnt(12)
    s_waitcnt lgkmcnt(0)
    s_barrier
    v_mfma_f32_32x32x16_bf16 v[64:79], a[24:27], a[44:47], v[64:79]
    ds_read_b128 a[20:23], v164 offset:32768
    ds_read_b64_tr_b16 a[0:1], v168 offset:16384
    ds_read_b64_tr_b16 a[2:3], v168 offset:18432
    v_mfma_f32_32x32x16_bf16 v[80:95], a[28:31], a[44:47], v[80:95]
    ds_read_b64_tr_b16 a[4:5], v169 offset:16384
    ds_read_b64_tr_b16 a[6:7], v169 offset:18432
    ds_read_b64_tr_b16 a[8:9], v170 offset:16384
    v_mfma_f32_32x32x16_bf16 v[96:111], a[32:35], a[44:47], v[96:111]
    ds_read_b64_tr_b16 a[10:11], v170 offset:18432
    ds_read_b64_tr_b16 a[12:13], v171 offset:16384
    ds_read_b64_tr_b16 a[14:15], v171 offset:18432
    v_mfma_f32_32x32x16_bf16 v[112:127], a[36:39], a[44:47], v[112:127]
    ds_read_b128 a[16:19], v160 offset:32768
    v_mfma_f32_32x32x16_bf16 v[0:15], a[24:27], a[40:43], v[0:15]
    s_add_u32 m0, s72, 114688
    s_add_u32 s78, s96, 0
    s_and_b32 s78, s78, 3
    s_lshl_b32 s78, s78, 7
    s_add_u32 s78, s78, s97
    s_lshl_b32 s91, s98, 18
    s_add_u32 s78, s78, s91
    buffer_load_dwordx4 v216, s[48:51], s78 offen lds
    v_mfma_f32_32x32x16_bf16 v[16:31], a[28:31], a[40:43], v[16:31]
    v_mfma_f32_32x32x16_bf16 v[32:47], a[32:35], a[40:43], v[32:47]
    buffer_load_dwordx4 v217, s[48:51], s78 offen offset:1024 lds
    v_mfma_f32_32x32x16_bf16 v[48:63], a[36:39], a[40:43], v[48:63]
    s_waitcnt lgkmcnt(7)
    v_mfma_f32_32x32x16_bf16 v[64:79], a[0:3], a[20:23], v[64:79]
    ds_read_b128 a[44:47], v165 offset:32768
    ds_read_b64_tr_b16 a[24:25], v168 offset:24576
    ds_read_b64_tr_b16 a[26:27], v168 offset:26624
    s_waitcnt lgkmcnt(8)
    v_mfma_f32_32x32x16_bf16 v[80:95], a[4:7], a[20:23], v[80:95]
    ds_read_b64_tr_b16 a[28:29], v169 offset:24576
    ds_read_b64_tr_b16 a[30:31], v169 offset:26624
    ds_read_b64_tr_b16 a[32:33], v170 offset:24576
    s_waitcnt lgkmcnt(9)
    v_mfma_f32_32x32x16_bf16 v[96:111], a[8:11], a[20:23], v[96:111]
    ds_read_b64_tr_b16 a[34:35], v170 offset:26624
    ds_read_b64_tr_b16 a[36:37], v171 offset:24576
    ds_read_b64_tr_b16 a[38:39], v171 offset:26624
    s_waitcnt lgkmcnt(10)
    v_mfma_f32_32x32x16_bf16 v[112:127], a[12:15], a[20:23], v[112:127]
    ds_read_b128 a[40:43], v161 offset:32768
    s_waitcnt lgkmcnt(10)
    v_mfma_f32_32x32x16_bf16 v[0:15], a[0:3], a[16:19], v[0:15]
    s_add_u32 m0, s72, 114688
    s_nop 0
    buffer_load_dwordx4 v218, s[48:51], s78 offen offset:2048 lds
    v_mfma_f32_32x32x16_bf16 v[16:31], a[4:7], a[16:19], v[16:31]
    v_mfma_f32_32x32x16_bf16 v[32:47], a[8:11], a[16:19], v[32:47]
    buffer_load_dwordx4 v219, s[48:51], s78 offen offset:3072 lds
    v_mfma_f32_32x32x16_bf16 v[48:63], a[12:15], a[16:19], v[48:63]
    ds_read_b128 a[48:51], v180
    ds_read_b128 a[52:55], v181
    ds_read_b128 a[56:59], v182
    ds_read_b128 a[60:63], v183
    s_waitcnt lgkmcnt(0)
    s_barrier
    v_mfma_f32_32x32x16_bf16 v[64:79], a[24:27], a[44:47], v[64:79]
    ds_read_b128 a[20:23], v166 offset:32768
    ds_read_b64_tr_b16 a[0:1], v168 offset:32768
    ds_read_b64_tr_b16 a[2:3], v168 offset:34816
    v_mfma_f32_32x32x16_bf16 v[80:95], a[28:31], a[44:47], v[80:95]
    ds_read_b64_tr_b16 a[4:5], v169 offset:32768
    ds_read_b64_tr_b16 a[6:7], v169 offset:34816
    ds_read_b64_tr_b16 a[8:9], v170 offset:32768
    v_mfma_f32_32x32x16_bf16 v[96:111], a[32:35], a[44:47], v[96:111]
    ds_read_b64_tr_b16 a[10:11], v170 offset:34816
    ds_read_b64_tr_b16 a[12:13], v171 offset:32768
    ds_read_b64_tr_b16 a[14:15], v171 offset:34816
    v_mfma_f32_32x32x16_bf16 v[112:127], a[36:39], a[44:47], v[112:127]
    ds_read_b128 a[16:19], v162 offset:32768
    v_mfma_f32_32x32x16_bf16 v[0:15], a[24:27], a[40:43], v[0:15]
    s_add_u32 m0, s72, 147456
    s_xor_b32 s91, s21, 128
    s_add_u32 s91, s91, s79
    buffer_load_dwordx4 v216, s[44:47], s91 offen lds
    v_mfma_f32_32x32x16_bf16 v[16:31], a[28:31], a[40:43], v[16:31]
    buffer_load_dwordx4 v217, s[44:47], s91 offen offset:1024 lds
    v_mfma_f32_32x32x16_bf16 v[32:47], a[32:35], a[40:43], v[32:47]
    buffer_load_dwordx4 v218, s[44:47], s91 offen offset:2048 lds
    v_mfma_f32_32x32x16_bf16 v[48:63], a[36:39], a[40:43], v[48:63]
    buffer_load_dwordx4 v219, s[44:47], s91 offen offset:3072 lds
    s_waitcnt lgkmcnt(7)
    v_mfma_f32_32x32x16_bf16 v[64:79], a[0:3], a[20:23], v[64:79]
    ds_read_b128 a[44:47], v167 offset:32768
    ds_read_b64_tr_b16 a[24:25], v168 offset:40960
    ds_read_b64_tr_b16 a[26:27], v168 offset:43008
    s_waitcnt lgkmcnt(8)
    v_mfma_f32_32x32x16_bf16 v[80:95], a[4:7], a[20:23], v[80:95]
    ds_read_b64_tr_b16 a[28:29], v169 offset:40960
    ds_read_b64_tr_b16 a[30:31], v169 offset:43008
    ds_read_b64_tr_b16 a[32:33], v170 offset:40960
    s_waitcnt lgkmcnt(9)
    v_mfma_f32_32x32x16_bf16 v[96:111], a[8:11], a[20:23], v[96:111]
    ds_read_b64_tr_b16 a[34:35], v170 offset:43008
    ds_read_b64_tr_b16 a[36:37], v171 offset:40960
    ds_read_b64_tr_b16 a[38:39], v171 offset:43008
    s_waitcnt lgkmcnt(10)
    v_mfma_f32_32x32x16_bf16 v[112:127], a[12:15], a[20:23], v[112:127]
    ds_read_b128 a[40:43], v163 offset:32768
    s_waitcnt lgkmcnt(10)
    v_mfma_f32_32x32x16_bf16 v[0:15], a[0:3], a[16:19], v[0:15]
    s_add_u32 m0, s72, 49152
    s_add_u32 s76, s96, 0
    s_and_b32 s76, s76, 3
    s_mul_i32 s76, s76, 57344
    s_add_u32 s76, s76, 28672
    buffer_load_dwordx4 v230, s[52:55], s76 offen lds
    v_mfma_f32_32x32x16_bf16 v[16:31], a[4:7], a[16:19], v[16:31]
    buffer_load_dwordx4 v231, s[52:55], s76 offen offset:1024 lds
    v_mfma_f32_32x32x16_bf16 v[32:47], a[8:11], a[16:19], v[32:47]
    buffer_load_dwordx4 v232, s[52:55], s76 offen offset:2048 lds
    v_mfma_f32_32x32x16_bf16 v[48:63], a[12:15], a[16:19], v[48:63]
    buffer_load_dwordx4 v233, s[52:55], s76 offen offset:3072 lds
    v_subrev_u32 v168, 49152, v168
    v_subrev_u32 v169, 49152, v169
    v_subrev_u32 v170, 49152, v170
    v_subrev_u32 v171, 49152, v171
    s_waitcnt vmcnt(16)
    s_waitcnt lgkmcnt(0)
    s_barrier
    v_mfma_f32_32x32x16_bf16 v[64:79], a[24:27], a[44:47], v[64:79]
    ds_read_b128 a[20:23], v164 offset:0
    ds_read_b64_tr_b16 a[0:1], v168 offset:0
    ds_read_b64_tr_b16 a[2:3], v168 offset:2048
    v_mfma_f32_32x32x16_bf16 v[80:95], a[28:31], a[44:47], v[80:95]
    ds_read_b64_tr_b16 a[4:5], v169 offset:0
    ds_read_b64_tr_b16 a[6:7], v169 offset:2048
    ds_read_b64_tr_b16 a[8:9], v170 offset:0
    v_mfma_f32_32x32x16_bf16 v[96:111], a[32:35], a[44:47], v[96:111]
    ds_read_b64_tr_b16 a[10:11], v170 offset:2048
    ds_read_b64_tr_b16 a[12:13], v171 offset:0
    ds_read_b64_tr_b16 a[14:15], v171 offset:2048
    v_mfma_f32_32x32x16_bf16 v[112:127], a[36:39], a[44:47], v[112:127]
    ds_read_b128 a[16:19], v160 offset:0
    v_mfma_f32_32x32x16_bf16 v[0:15], a[24:27], a[40:43], v[0:15]
    s_add_u32 m0, s72, 65536
    s_add_u32 s75, s96, 1
    s_and_b32 s75, s75, 3
    s_mul_i32 s75, s75, 57344
    buffer_load_dwordx4 v230, s[52:55], s75 offen lds
    v_mfma_f32_32x32x16_bf16 v[16:31], a[28:31], a[40:43], v[16:31]
    v_mfma_f32_32x32x16_bf16 v[32:47], a[32:35], a[40:43], v[32:47]
    buffer_load_dwordx4 v231, s[52:55], s75 offen offset:1024 lds
    v_mfma_f32_32x32x16_bf16 v[48:63], a[36:39], a[40:43], v[48:63]
    s_waitcnt lgkmcnt(7)
    v_mfma_f32_32x32x16_bf16 v[64:79], a[0:3], a[20:23], v[64:79]
    ds_read_b128 a[44:47], v165 offset:0
    ds_read_b64_tr_b16 a[24:25], v168 offset:8192
    ds_read_b64_tr_b16 a[26:27], v168 offset:10240
    s_waitcnt lgkmcnt(8)
    v_mfma_f32_32x32x16_bf16 v[80:95], a[4:7], a[20:23], v[80:95]
    ds_read_b64_tr_b16 a[28:29], v169 offset:8192
    ds_read_b64_tr_b16 a[30:31], v169 offset:10240
    ds_read_b64_tr_b16 a[32:33], v170 offset:8192
    s_waitcnt lgkmcnt(9)
    v_mfma_f32_32x32x16_bf16 v[96:111], a[8:11], a[20:23], v[96:111]
    ds_read_b64_tr_b16 a[34:35], v170 offset:10240
    ds_read_b64_tr_b16 a[36:37], v171 offset:8192
    ds_read_b64_tr_b16 a[38:39], v171 offset:10240
    s_waitcnt lgkmcnt(10)
    v_mfma_f32_32x32x16_bf16 v[112:127], a[12:15], a[20:23], v[112:127]
    ds_read_b128 a[40:43], v161 offset:0
    s_waitcnt lgkmcnt(10)
    v_mfma_f32_32x32x16_bf16 v[0:15], a[0:3], a[16:19], v[0:15]
    buffer_load_dwordx4 v232, s[52:55], s75 offen offset:2048 lds
    v_mfma_f32_32x32x16_bf16 v[16:31], a[4:7], a[16:19], v[16:31]
    v_mfma_f32_32x32x16_bf16 v[32:47], a[8:11], a[16:19], v[32:47]
    buffer_load_dwordx4 v233, s[52:55], s75 offen offset:3072 lds
    v_mfma_f32_32x32x16_bf16 v[48:63], a[12:15], a[16:19], v[48:63]
    s_waitcnt lgkmcnt(0)
    s_barrier
    v_mfma_f32_32x32x16_bf16 v[64:79], a[24:27], a[44:47], v[64:79]
    ds_read_b128 a[20:23], v166 offset:0
    ds_read_b64_tr_b16 a[0:1], v168 offset:16384
    ds_read_b64_tr_b16 a[2:3], v168 offset:18432
    v_mfma_f32_32x32x16_bf16 v[80:95], a[28:31], a[44:47], v[80:95]
    ds_read_b64_tr_b16 a[4:5], v169 offset:16384
    ds_read_b64_tr_b16 a[6:7], v169 offset:18432
    ds_read_b64_tr_b16 a[8:9], v170 offset:16384
    v_mfma_f32_32x32x16_bf16 v[96:111], a[32:35], a[44:47], v[96:111]
    ds_read_b64_tr_b16 a[10:11], v170 offset:18432
    ds_read_b64_tr_b16 a[12:13], v171 offset:16384
    ds_read_b64_tr_b16 a[14:15], v171 offset:18432
    v_mfma_f32_32x32x16_bf16 v[112:127], a[36:39], a[44:47], v[112:127]
    ds_read_b128 a[16:19], v162 offset:0
    v_mfma_f32_32x32x16_bf16 v[0:15], a[24:27], a[40:43], v[0:15]
    s_add_u32 m0, s72, 131072
    s_add_u32 s77, s96, 1
    s_and_b32 s77, s77, 3
    s_lshl_b32 s77, s77, 7
    s_add_u32 s77, s77, s97
    s_lshl_b32 s91, s98, 18
    s_add_u32 s77, s77, s91
    buffer_load_dwordx4 v216, s[48:51], s77 offen lds
    v_mfma_f32_32x32x16_bf16 v[16:31], a[28:31], a[40:43], v[16:31]
    buffer_load_dwordx4 v217, s[48:51], s77 offen offset:1024 lds
    v_mfma_f32_32x32x16_bf16 v[32:47], a[32:35], a[40:43], v[32:47]
    s_add_u32 m0, s72, 131072
    s_nop 0
    buffer_load_dwordx4 v218, s[48:51], s77 offen offset:2048 lds
    v_mfma_f32_32x32x16_bf16 v[48:63], a[36:39], a[40:43], v[48:63]
    buffer_load_dwordx4 v219, s[48:51], s77 offen offset:3072 lds
    s_waitcnt lgkmcnt(7)
    v_mfma_f32_32x32x16_bf16 v[64:79], a[0:3], a[20:23], v[64:79]
    ds_read_b128 a[44:47], v167 offset:0
    ds_read_b64_tr_b16 a[24:25], v168 offset:24576
    ds_read_b64_tr_b16 a[26:27], v168 offset:26624
    s_waitcnt lgkmcnt(8)
    v_mfma_f32_32x32x16_bf16 v[80:95], a[4:7], a[20:23], v[80:95]
    ds_read_b64_tr_b16 a[28:29], v169 offset:24576
    ds_read_b64_tr_b16 a[30:31], v169 offset:26624
    ds_read_b64_tr_b16 a[32:33], v170 offset:24576
    s_waitcnt lgkmcnt(9)
    v_mfma_f32_32x32x16_bf16 v[96:111], a[8:11], a[20:23], v[96:111]
    ds_read_b64_tr_b16 a[34:35], v170 offset:26624
    ds_read_b64_tr_b16 a[36:37], v171 offset:24576
    ds_read_b64_tr_b16 a[38:39], v171 offset:26624
    s_waitcnt lgkmcnt(10)
    v_mfma_f32_32x32x16_bf16 v[112:127], a[12:15], a[20:23], v[112:127]
    ds_read_b128 a[40:43], v163 offset:0
    s_waitcnt lgkmcnt(10)
    v_mfma_f32_32x32x16_bf16 v[0:15], a[0:3], a[16:19], v[0:15]
    s_add_u32 m0, s72, 81920
    s_add_u32 s76, s96, 1
    s_and_b32 s76, s76, 3
    s_mul_i32 s76, s76, 57344
    s_add_u32 s76, s76, 28672
    buffer_load_dwordx4 v230, s[52:55], s76 offen lds
    v_mfma_f32_32x32x16_bf16 v[16:31], a[4:7], a[16:19], v[16:31]
    buffer_load_dwordx4 v231, s[52:55], s76 offen offset:1024 lds
    v_mfma_f32_32x32x16_bf16 v[32:47], a[8:11], a[16:19], v[32:47]
    buffer_load_dwordx4 v232, s[52:55], s76 offen offset:2048 lds
    v_mfma_f32_32x32x16_bf16 v[48:63], a[12:15], a[16:19], v[48:63]
    buffer_load_dwordx4 v233, s[52:55], s76 offen offset:3072 lds
    s_waitcnt vmcnt(16)
    ds_read_b128 a[64:67], v180
    ds_read_b128 a[68:71], v181
    ds_read_b128 a[72:75], v182
    ds_read_b128 a[76:79], v183
    v_add_u32 v224, 114688, v220
    v_add_u32 v225, 114688, v221
    v_add_u32 v226, 114688, v222
    v_add_u32 v227, 114688, v223
    s_waitcnt lgkmcnt(0)
    s_barrier
    v_mfma_f32_32x32x16_bf16 v[64:79], a[24:27], a[44:47], v[64:79]
    ds_read_b128 v[208:211], v224
    ds_read_b64_tr_b16 a[112:113], v228 offset:32768
    ds_read_b64_tr_b16 a[114:115], v228 offset:33280
    v_mfma_f32_32x32x16_bf16 v[80:95], a[28:31], a[44:47], v[80:95]
    ds_read_b64_tr_b16 a[116:117], v229 offset:32768
    ds_read_b64_tr_b16 a[118:119], v229 offset:33280
    ds_read_b64_tr_b16 a[120:121], v228 offset:36864
    v_mfma_f32_32x32x16_bf16 v[96:111], a[32:35], a[44:47], v[96:111]
    ds_read_b64_tr_b16 a[122:123], v228 offset:37376
    ds_read_b64_tr_b16 a[124:125], v229 offset:36864
    ds_read_b64_tr_b16 a[126:127], v229 offset:37376
    v_mfma_f32_32x32x16_bf16 v[112:127], a[36:39], a[44:47], v[112:127]
    v_cvt_pk_bf16_f32 v64, v64, v65
    v_cvt_pk_bf16_f32 v65, v66, v67
    v_cvt_pk_bf16_f32 v66, v68, v69
    v_cvt_pk_bf16_f32 v67, v70, v71
    v_mfma_f32_32x32x16_bf16 v[0:15], a[24:27], a[40:43], v[0:15]
    v_cvt_pk_bf16_f32 v68, v72, v73
    v_cvt_pk_bf16_f32 v69, v74, v75
    v_cvt_pk_bf16_f32 v70, v76, v77
    v_cvt_pk_bf16_f32 v71, v78, v79
    v_cvt_pk_bf16_f32 v80, v80, v81
    v_cvt_pk_bf16_f32 v81, v82, v83
    v_mfma_f32_32x32x16_bf16 v[16:31], a[28:31], a[40:43], v[16:31]
    v_cvt_pk_bf16_f32 v82, v84, v85
    v_cvt_pk_bf16_f32 v83, v86, v87
    v_cvt_pk_bf16_f32 v84, v88, v89
    v_cvt_pk_bf16_f32 v85, v90, v91
    v_cvt_pk_bf16_f32 v86, v92, v93
    v_cvt_pk_bf16_f32 v87, v94, v95
    v_mfma_f32_32x32x16_bf16 v[32:47], a[32:35], a[40:43], v[32:47]
    v_cvt_pk_bf16_f32 v96, v96, v97
    v_cvt_pk_bf16_f32 v97, v98, v99
    v_cvt_pk_bf16_f32 v98, v100, v101
    v_cvt_pk_bf16_f32 v99, v102, v103
    v_cvt_pk_bf16_f32 v100, v104, v105
    v_cvt_pk_bf16_f32 v101, v106, v107
    v_mfma_f32_32x32x16_bf16 v[48:63], a[36:39], a[40:43], v[48:63]
    v_cvt_pk_bf16_f32 v102, v108, v109
    v_cvt_pk_bf16_f32 v103, v110, v111
    v_cvt_pk_bf16_f32 v112, v112, v113
    v_cvt_pk_bf16_f32 v113, v114, v115
    v_cvt_pk_bf16_f32 v114, v116, v117
    v_cvt_pk_bf16_f32 v115, v118, v119
    v_mfma_f32_32x32x16_bf16 v[144:159], a[80:83], v[64:67], 0
    v_cvt_pk_bf16_f32 v116, v120, v121
    v_cvt_pk_bf16_f32 v117, v122, v123
    v_cvt_pk_bf16_f32 v118, v124, v125
    v_cvt_pk_bf16_f32 v119, v126, v127
    v_mfma_f32_32x32x16_bf16 v[144:159], a[84:87], v[68:71], v[144:159]
    v_mfma_f32_32x32x16_bf16 v[144:159], a[88:91], v[80:83], v[144:159]
    v_cvt_pk_bf16_f32 v0, v0, v1
    v_cvt_pk_bf16_f32 v1, v2, v3
    v_cvt_pk_bf16_f32 v2, v4, v5
    v_cvt_pk_bf16_f32 v3, v6, v7
    v_cvt_pk_bf16_f32 v4, v8, v9
    v_cvt_pk_bf16_f32 v5, v10, v11
    v_mfma_f32_32x32x16_bf16 v[144:159], a[92:95], v[84:87], v[144:159]
    v_cvt_pk_bf16_f32 v6, v12, v13
    v_cvt_pk_bf16_f32 v7, v14, v15
    v_cvt_pk_bf16_f32 v16, v16, v17
    v_cvt_pk_bf16_f32 v17, v18, v19
    v_cvt_pk_bf16_f32 v18, v20, v21
    v_mfma_f32_32x32x16_bf16 v[144:159], a[96:99], v[96:99], v[144:159]
    v_cvt_pk_bf16_f32 v19, v22, v23
    v_cvt_pk_bf16_f32 v20, v24, v25
    v_cvt_pk_bf16_f32 v21, v26, v27
    v_cvt_pk_bf16_f32 v22, v28, v29
    v_cvt_pk_bf16_f32 v23, v30, v31
    v_mfma_f32_32x32x16_bf16 v[144:159], a[100:103], v[100:103], v[144:159]
    v_cvt_pk_bf16_f32 v32, v32, v33
    v_cvt_pk_bf16_f32 v33, v34, v35
    v_cvt_pk_bf16_f32 v34, v36, v37
    v_cvt_pk_bf16_f32 v35, v38, v39
    v_cvt_pk_bf16_f32 v36, v40, v41
    v_cvt_pk_bf16_f32 v37, v42, v43
    v_mfma_f32_32x32x16_bf16 v[144:159], a[104:107], v[112:115], v[144:159]
    v_cvt_pk_bf16_f32 v38, v44, v45
    v_cvt_pk_bf16_f32 v39, v46, v47
    v_cvt_pk_bf16_f32 v48, v48, v49
    v_cvt_pk_bf16_f32 v49, v50, v51
    v_cvt_pk_bf16_f32 v50, v52, v53
    v_mfma_f32_32x32x16_bf16 v[144:159], a[108:111], v[116:119], v[144:159]
    v_cvt_pk_bf16_f32 v51, v54, v55
    v_cvt_pk_bf16_f32 v52, v56, v57
    v_cvt_pk_bf16_f32 v53, v58, v59
    v_cvt_pk_bf16_f32 v54, v60, v61
    v_cvt_pk_bf16_f32 v55, v62, v63
    v_mfma_f32_32x32x16_bf16 v[128:143], a[48:51], v[0:3], 0
    v_mfma_f32_32x32x16_bf16 v[128:143], a[52:55], v[4:7], v[128:143]
    v_mfma_f32_32x32x16_bf16 v[128:143], a[56:59], v[16:19], v[128:143]
    s_nop 3
    ds_write_b128 v236, v[144:147] offset:0
    v_mfma_f32_32x32x16_bf16 v[128:143], a[60:63], v[20:23], v[128:143]
    ds_write_b128 v236, v[148:151] offset:1024
    v_mfma_f32_32x32x16_bf16 v[128:143], a[64:67], v[32:35], v[128:143]
    ds_write_b128 v236, v[152:155] offset:2048
    v_mfma_f32_32x32x16_bf16 v[128:143], a[68:71], v[36:39], v[128:143]
    ds_write_b128 v236, v[156:159] offset:3072
    v_mfma_f32_32x32x16_bf16 v[128:143], a[72:75], v[48:51], v[128:143]
    v_mfma_f32_32x32x16_bf16 v[128:143], a[76:79], v[52:55], v[128:143]
    s_waitcnt lgkmcnt(10)
    v_mfma_f32_32x32x16_bf16 v[0:15], v[208:211], a[112:115], 0
    ds_read_b128 v[212:215], v225
    ds_read_b64_tr_b16 a[128:129], v228 offset:34816
    ds_read_b64_tr_b16 a[130:131], v228 offset:35328
    s_waitcnt lgkmcnt(11)
    v_mfma_f32_32x32x16_bf16 v[16:31], v[208:211], a[116:119], 0
    ds_read_b64_tr_b16 a[132:133], v229 offset:34816
    ds_read_b64_tr_b16 a[134:135], v229 offset:35328
    ds_read_b64_tr_b16 a[136:137], v228 offset:38912
    s_waitcnt lgkmcnt(12)
    v_mfma_f32_32x32x16_bf16 v[32:47], v[208:211], a[120:123], 0
    ds_read_b64_tr_b16 a[138:139], v228 offset:39424
    ds_read_b64_tr_b16 a[140:141], v229 offset:38912
    ds_read_b64_tr_b16 a[142:143], v229 offset:39424
    s_waitcnt lgkmcnt(13)
    v_mfma_f32_32x32x16_bf16 v[48:63], v[208:211], a[124:127], 0
    v_add_u32 v228, 49152, v228
    v_add_u32 v229, 49152, v229
    s_waitcnt vmcnt(12)
    s_waitcnt lgkmcnt(0)
    s_barrier
    v_mfma_f32_32x32x16_bf16 v[0:15], v[212:215], a[128:131], v[0:15]
    ds_read_b128 v[208:211], v226
    ds_read_b64_tr_b16 a[144:145], v228 offset:0
    ds_read_b64_tr_b16 a[146:147], v228 offset:512
    ds_read_b128 v[192:195], v237 offset:0
    ds_read_b128 v[196:199], v237 offset:1024
    v_mfma_f32_32x32x16_bf16 v[16:31], v[212:215], a[132:135], v[16:31]
    ds_read_b64_tr_b16 a[148:149], v229 offset:0
    ds_read_b64_tr_b16 a[150:151], v229 offset:512
    ds_read_b64_tr_b16 a[152:153], v228 offset:4096
    ds_read_b128 v[200:203], v237 offset:2048
    ds_read_b128 v[204:207], v237 offset:3072
    v_mfma_f32_32x32x16_bf16 v[32:47], v[212:215], a[136:139], v[32:47]
    ds_read_b64_tr_b16 a[154:155], v228 offset:4608
    ds_read_b64_tr_b16 a[156:157], v229 offset:4096
    ds_read_b64_tr_b16 a[158:159], v229 offset:4608
    s_add_u32 m0, s72, 0
    s_add_u32 s75, s96, 2
    s_and_b32 s75, s75, 3
    s_mul_i32 s75, s75, 57344
    buffer_load_dwordx4 v230, s[52:55], s75 offen lds
    buffer_load_dwordx4 v231, s[52:55], s75 offen offset:1024 lds
    v_mfma_f32_32x32x16_bf16 v[48:63], v[212:215], a[140:143], v[48:63]
    s_waitcnt lgkmcnt(9)
    v_add_f32 v128, v128, v192
    v_add_f32 v129, v129, v193
    v_add_f32 v130, v130, v194
    v_add_f32 v131, v131, v195
    s_waitcnt lgkmcnt(8)
    v_add_f32 v132, v132, v196
    v_add_f32 v133, v133, v197
    v_add_f32 v134, v134, v198
    buffer_load_dwordx4 v232, s[52:55], s75 offen offset:2048 lds
    v_mfma_f32_32x32x16_bf16 v[0:15], v[208:211], a[144:147], v[0:15]
    ds_read_b128 v[212:215], v227
    ds_read_b64_tr_b16 a[160:161], v228 offset:2048
    ds_read_b64_tr_b16 a[162:163], v228 offset:2560
    v_add_f32 v135, v135, v199
    s_waitcnt lgkmcnt(7)
    v_add_f32 v136, v136, v200
    v_add_f32 v137, v137, v201
    v_add_f32 v138, v138, v202
    v_add_f32 v139, v139, v203
    s_waitcnt lgkmcnt(6)
    v_add_f32 v140, v140, v204
    buffer_load_dwordx4 v233, s[52:55], s75 offen offset:3072 lds
    v_mfma_f32_32x32x16_bf16 v[16:31], v[208:211], a[148:151], v[16:31]
    ds_read_b64_tr_b16 a[164:165], v229 offset:2048
    ds_read_b64_tr_b16 a[166:167], v229 offset:2560
    ds_read_b64_tr_b16 a[168:169], v228 offset:6144
    v_add_f32 v141, v141, v205
    v_add_f32 v142, v142, v206
    v_add_f32 v143, v143, v207
    v_max3_f32 v245, v128, v129, v130
    v_max3_f32 v245, v245, v131, v132
    v_max3_f32 v245, v245, v133, v134
    s_add_u32 m0, s72, 98304
    s_add_u32 s78, s96, 2
    s_and_b32 s78, s78, 3
    s_lshl_b32 s78, s78, 7
    s_add_u32 s78, s78, s97
    s_lshl_b32 s91, s98, 18
    s_add_u32 s78, s78, s91
    buffer_load_dwordx4 v216, s[48:51], s78 offen lds
    buffer_load_dwordx4 v217, s[48:51], s78 offen offset:1024 lds
    s_waitcnt lgkmcnt(8)
    v_mfma_f32_32x32x16_bf16 v[32:47], v[208:211], a[152:155], v[32:47]
    ds_read_b64_tr_b16 a[170:171], v228 offset:6656
    ds_read_b64_tr_b16 a[172:173], v229 offset:6144
    ds_read_b64_tr_b16 a[174:175], v229 offset:6656
    v_max3_f32 v245, v245, v135, v136
    v_max3_f32 v245, v245, v137, v138
    v_max3_f32 v245, v245, v139, v140
    v_max3_f32 v245, v245, v141, v142
    v_max_f32 v245, v245, v143
    v_mov_b32 v246, v245
    s_add_u32 m0, s72, 98304
    s_nop 0
    buffer_load_dwordx4 v218, s[48:51], s78 offen offset:2048 lds
    s_waitcnt lgkmcnt(9)
    v_mfma_f32_32x32x16_bf16 v[48:63], v[208:211], a[156:159], v[48:63]
    v_permlane32_swap_b32 v245, v246
    v_max_f32 v245, v245, v246
    s_mov_b32 s3, 0x3db8aa3b
    v_mul_f32 v245, s3, v245
    v_fma_f32 v128, v128, s3, -v245
    v_fma_f32 v129, v129, s3, -v245
    buffer_load_dwordx4 v219, s[48:51], s78 offen offset:3072 lds
    v_add_u32 v224, 131072, v220
    v_add_u32 v225, 131072, v221
    v_add_u32 v226, 131072, v222
    v_add_u32 v227, 131072, v223
    s_waitcnt vmcnt(16)
    s_waitcnt vmcnt(12)
    s_waitcnt lgkmcnt(0)
    s_barrier
    v_mfma_f32_32x32x16_bf16 v[0:15], v[212:215], a[160:163], v[0:15]
    ds_read_b128 v[208:211], v224
    ds_read_b64_tr_b16 a[176:177], v228 offset:16384
    ds_read_b64_tr_b16 a[178:179], v228 offset:16896
    v_fma_f32 v130, v130, s3, -v245
    v_fma_f32 v131, v131, s3, -v245
    v_fma_f32 v132, v132, s3, -v245
    v_fma_f32 v133, v133, s3, -v245
    v_fma_f32 v134, v134, s3, -v245
    v_mfma_f32_32x32x16_bf16 v[16:31], v[212:215], a[164:167], v[16:31]
    ds_read_b64_tr_b16 a[180:181], v229 offset:16384
    ds_read_b64_tr_b16 a[182:183], v229 offset:16896
    ds_read_b64_tr_b16 a[184:185], v228 offset:20480
    v_fma_f32 v135, v135, s3, -v245
    v_fma_f32 v136, v136, s3, -v245
    v_fma_f32 v137, v137, s3, -v245
    v_fma_f32 v138, v138, s3, -v245
    v_mfma_f32_32x32x16_bf16 v[32:47], v[212:215], a[168:171], v[32:47]
    ds_read_b64_tr_b16 a[186:187], v228 offset:20992
    ds_read_b64_tr_b16 a[188:189], v229 offset:20480
    ds_read_b64_tr_b16 a[190:191], v229 offset:20992
    v_fma_f32 v139, v139, s3, -v245
    v_fma_f32 v140, v140, s3, -v245
    v_fma_f32 v141, v141, s3, -v245
    v_fma_f32 v142, v142, s3, -v245
    s_add_u32 m0, s72, 16384
    s_add_u32 s76, s96, 2
    s_and_b32 s76, s76, 3
    s_mul_i32 s76, s76, 57344
    s_add_u32 s76, s76, 28672
    buffer_load_dwordx4 v230, s[52:55], s76 offen lds
    buffer_load_dwordx4 v231, s[52:55], s76 offen offset:1024 lds
    v_mfma_f32_32x32x16_bf16 v[48:63], v[212:215], a[172:175], v[48:63]
    v_fma_f32 v143, v143, s3, -v245
    v_exp_f32 v128, v128
    v_exp_f32 v129, v129
    v_exp_f32 v130, v130
    buffer_load_dwordx4 v232, s[52:55], s76 offen offset:2048 lds
    s_waitcnt lgkmcnt(6)
    v_mfma_f32_32x32x16_bf16 v[0:15], v[208:211], a[176:179], v[0:15]
    ds_read_b128 v[212:215], v225
    ds_read_b64_tr_b16 a[192:193], v228 offset:18432
    ds_read_b64_tr_b16 a[194:195], v228 offset:18944
    v_exp_f32 v131, v131
    v_exp_f32 v132, v132
    v_exp_f32 v133, v133
    v_exp_f32 v134, v134
    buffer_load_dwordx4 v233, s[52:55], s76 offen offset:3072 lds
    s_waitcnt lgkmcnt(7)
    v_mfma_f32_32x32x16_bf16 v[16:31], v[208:211], a[180:183], v[16:31]
    ds_read_b64_tr_b16 a[196:197], v229 offset:18432
    ds_read_b64_tr_b16 a[198:199], v229 offset:18944
    ds_read_b64_tr_b16 a[200:201], v228 offset:22528
    v_exp_f32 v135, v135
    v_exp_f32 v136, v136
    v_exp_f32 v137, v137
    v_exp_f32 v138, v138
    s_add_u32 m0, s72, 32768
    s_add_u32 s75, s96, 3
    s_and_b32 s75, s75, 3
    s_mul_i32 s75, s75, 57344
    buffer_load_dwordx4 v230, s[52:55], s75 offen lds
    buffer_load_dwordx4 v231, s[52:55], s75 offen offset:1024 lds
    s_waitcnt lgkmcnt(8)
    v_mfma_f32_32x32x16_bf16 v[32:47], v[208:211], a[184:187], v[32:47]
    ds_read_b64_tr_b16 a[202:203], v228 offset:23040
    ds_read_b64_tr_b16 a[204:205], v229 offset:22528
    ds_read_b64_tr_b16 a[206:207], v229 offset:23040
    v_exp_f32 v139, v139
    v_exp_f32 v140, v140
    v_exp_f32 v141, v141
    v_exp_f32 v142, v142
    buffer_load_dwordx4 v232, s[52:55], s75 offen offset:2048 lds
    s_waitcnt lgkmcnt(9)
    v_mfma_f32_32x32x16_bf16 v[48:63], v[208:211], a[188:191], v[48:63]
    v_exp_f32 v143, v143
    v_add_f32 v246, v128, v129
    v_add_f32 v247, v130, v131
    v_add_f32 v246, v246, v132
    buffer_load_dwordx4 v233, s[52:55], s75 offen offset:3072 lds
    s_waitcnt vmcnt(16)
    s_waitcnt lgkmcnt(0)
    s_barrier
    v_mfma_f32_32x32x16_bf16 v[0:15], v[212:215], a[192:195], v[0:15]
    ds_read_b128 v[208:211], v226
    ds_read_b64_tr_b16 a[208:209], v228 offset:32768
    ds_read_b64_tr_b16 a[210:211], v228 offset:33280
    v_add_f32 v247, v247, v133
    v_add_f32 v246, v246, v134
    v_add_f32 v247, v247, v135
    v_add_f32 v246, v246, v136
    v_add_f32 v247, v247, v137
    v_mfma_f32_32x32x16_bf16 v[16:31], v[212:215], a[196:199], v[16:31]
    ds_read_b64_tr_b16 a[212:213], v229 offset:32768
    ds_read_b64_tr_b16 a[214:215], v229 offset:33280
    ds_read_b64_tr_b16 a[216:217], v228 offset:36864
    v_add_f32 v246, v246, v138
    v_add_f32 v247, v247, v139
    v_add_f32 v246, v246, v140
    v_add_f32 v247, v247, v141
    v_add_f32 v246, v246, v142
    v_mfma_f32_32x32x16_bf16 v[32:47], v[212:215], a[200:203], v[32:47]
    ds_read_b64_tr_b16 a[218:219], v228 offset:37376
    ds_read_b64_tr_b16 a[220:221], v229 offset:36864
    ds_read_b64_tr_b16 a[222:223], v229 offset:37376
    v_add_f32 v247, v247, v143
    v_add_f32 v246, v246, v247
    v_mov_b32 v247, v246
    s_nop 1
    v_permlane32_swap_b32 v246, v247
    v_add_f32 v246, v246, v247
    s_add_u32 m0, s72, 114688
    s_add_u32 s77, s96, 3
    s_and_b32 s77, s77, 3
    s_lshl_b32 s77, s77, 7
    s_add_u32 s77, s77, s97
    s_lshl_b32 s91, s98, 18
    s_add_u32 s77, s77, s91
    buffer_load_dwordx4 v216, s[48:51], s77 offen lds
    buffer_load_dwordx4 v217, s[48:51], s77 offen offset:1024 lds
    v_mfma_f32_32x32x16_bf16 v[48:63], v[212:215], a[204:207], v[48:63]
    v_rcp_f32 v246, v246
    s_nop 0
    v_mul_f32 v128, v128, v246
    v_mul_f32 v129, v129, v246
    v_mul_f32 v130, v130, v246
    v_mul_f32 v131, v131, v246
    s_add_u32 m0, s72, 114688
    s_nop 0
    buffer_load_dwordx4 v218, s[48:51], s77 offen offset:2048 lds
    s_waitcnt lgkmcnt(6)
    v_mfma_f32_32x32x16_bf16 v[0:15], v[208:211], a[208:211], v[0:15]
    ds_read_b128 v[212:215], v227
    ds_read_b64_tr_b16 a[224:225], v228 offset:34816
    ds_read_b64_tr_b16 a[226:227], v228 offset:35328
    v_mul_f32 v132, v132, v246
    v_mul_f32 v133, v133, v246
    v_mul_f32 v134, v134, v246
    v_mul_f32 v135, v135, v246
    v_mul_f32 v136, v136, v246
    buffer_load_dwordx4 v219, s[48:51], s77 offen offset:3072 lds
    s_waitcnt lgkmcnt(7)
    v_mfma_f32_32x32x16_bf16 v[16:31], v[208:211], a[212:215], v[16:31]
    ds_read_b64_tr_b16 a[228:229], v229 offset:34816
    ds_read_b64_tr_b16 a[230:231], v229 offset:35328
    ds_read_b64_tr_b16 a[232:233], v228 offset:38912
    v_mul_f32 v137, v137, v246
    v_mul_f32 v138, v138, v246
    v_mul_f32 v139, v139, v246
    v_mul_f32 v140, v140, v246
    v_mul_f32 v141, v141, v246
    s_add_u32 m0, s72, 49152
    s_add_u32 s76, s96, 3
    s_and_b32 s76, s76, 3
    s_mul_i32 s76, s76, 57344
    s_add_u32 s76, s76, 28672
    buffer_load_dwordx4 v230, s[52:55], s76 offen lds
    buffer_load_dwordx4 v231, s[52:55], s76 offen offset:1024 lds
    s_waitcnt lgkmcnt(8)
    v_mfma_f32_32x32x16_bf16 v[32:47], v[208:211], a[216:219], v[32:47]
    ds_read_b64_tr_b16 a[234:235], v228 offset:39424
    ds_read_b64_tr_b16 a[236:237], v229 offset:38912
    ds_read_b64_tr_b16 a[238:239], v229 offset:39424
    v_mul_f32 v142, v142, v246
    v_mul_f32 v143, v143, v246
    v_cvt_pk_bf16_f32 v128, v128, v129
    v_cvt_pk_bf16_f32 v129, v130, v131
    v_cvt_pk_bf16_f32 v130, v132, v133
    buffer_load_dwordx4 v232, s[52:55], s76 offen offset:2048 lds
    s_waitcnt lgkmcnt(9)
    v_mfma_f32_32x32x16_bf16 v[48:63], v[208:211], a[220:223], v[48:63]
    v_cvt_pk_bf16_f32 v131, v134, v135
    v_cvt_pk_bf16_f32 v132, v136, v137
    v_cvt_pk_bf16_f32 v133, v138, v139
    v_cvt_pk_bf16_f32 v134, v140, v141
    v_cvt_pk_bf16_f32 v135, v142, v143
    buffer_store_dwordx4 v[128:131], v234, s[56:59], s82 offen offset:0 sc1
    buffer_store_dwordx4 v[132:135], v234, s[56:59], s82 offen offset:1024 sc1
    buffer_load_dwordx4 v233, s[52:55], s76 offen offset:3072 lds
    v_subrev_u32 v228, 49152, v228
    v_subrev_u32 v229, 49152, v229
    v_add_u32 v224, 98304, v220
    v_add_u32 v225, 98304, v221
    v_add_u32 v226, 98304, v222
    v_add_u32 v227, 98304, v223
    s_waitcnt vmcnt(22)
    s_waitcnt vmcnt(18)
    s_waitcnt lgkmcnt(0)
    s_barrier
    v_mfma_f32_32x32x16_bf16 v[0:15], v[212:215], a[224:227], v[0:15]
    ds_read_b128 v[208:211], v224
    ds_read_b64_tr_b16 a[240:241], v228 offset:0
    ds_read_b64_tr_b16 a[242:243], v228 offset:512
    v_mfma_f32_32x32x16_bf16 v[16:31], v[212:215], a[228:231], v[16:31]
    ds_read_b64_tr_b16 a[244:245], v229 offset:0
    ds_read_b64_tr_b16 a[246:247], v229 offset:512
    ds_read_b64_tr_b16 a[248:249], v228 offset:4096
    v_mfma_f32_32x32x16_bf16 v[32:47], v[212:215], a[232:235], v[32:47]
    ds_read_b64_tr_b16 a[250:251], v228 offset:4608
    ds_read_b64_tr_b16 a[252:253], v229 offset:4096
    ds_read_b64_tr_b16 a[254:255], v229 offset:4608
    s_add_u32 m0, s72, 65536
    s_add_u32 s78, s96, 0
    s_and_b32 s78, s78, 3
    s_lshl_b32 s78, s78, 7
    s_add_u32 s78, s78, s97
    s_lshl_b32 s91, s99, 18
    s_add_u32 s78, s78, s91
    buffer_load_dwordx4 v216, s[48:51], s78 offen lds
    buffer_load_dwordx4 v217, s[48:51], s78 offen offset:1024 lds
    v_mfma_f32_32x32x16_bf16 v[48:63], v[212:215], a[236:239], v[48:63]
    s_add_u32 m0, s72, 65536
    s_nop 0
    buffer_load_dwordx4 v218, s[48:51], s78 offen offset:2048 lds
    s_waitcnt lgkmcnt(6)
    v_mfma_f32_32x32x16_bf16 v[0:15], v[208:211], a[240:243], v[0:15]
    ds_read_b128 v[212:215], v225
    ds_read_b64_tr_b16 a[0:1], v228 offset:2048
    ds_read_b64_tr_b16 a[2:3], v228 offset:2560
    buffer_load_dwordx4 v219, s[48:51], s78 offen offset:3072 lds
    s_waitcnt lgkmcnt(7)
    v_mfma_f32_32x32x16_bf16 v[16:31], v[208:211], a[244:247], v[16:31]
    ds_read_b64_tr_b16 a[4:5], v229 offset:2048
    ds_read_b64_tr_b16 a[6:7], v229 offset:2560
    ds_read_b64_tr_b16 a[8:9], v228 offset:6144
    s_add_u32 m0, s72, 81920
    s_add_u32 s77, s96, 1
    s_and_b32 s77, s77, 3
    s_lshl_b32 s77, s77, 7
    s_add_u32 s77, s77, s97
    s_lshl_b32 s91, s99, 18
    s_add_u32 s77, s77, s91
    buffer_load_dwordx4 v216, s[48:51], s77 offen lds
    buffer_load_dwordx4 v217, s[48:51], s77 offen offset:1024 lds
    s_waitcnt lgkmcnt(8)
    v_mfma_f32_32x32x16_bf16 v[32:47], v[208:211], a[248:251], v[32:47]
    ds_read_b64_tr_b16 a[10:11], v228 offset:6656
    ds_read_b64_tr_b16 a[12:13], v229 offset:6144
    ds_read_b64_tr_b16 a[14:15], v229 offset:6656
    s_add_u32 m0, s72, 81920
    s_nop 0
    buffer_load_dwordx4 v218, s[48:51], s77 offen offset:2048 lds
    s_waitcnt lgkmcnt(9)
    v_mfma_f32_32x32x16_bf16 v[48:63], v[208:211], a[252:255], v[48:63]
    buffer_load_dwordx4 v219, s[48:51], s77 offen offset:3072 lds
    s_waitcnt vmcnt(22)
    s_waitcnt lgkmcnt(0)
    s_barrier
    v_mfma_f32_32x32x16_bf16 v[0:15], v[212:215], a[0:3], v[0:15]
    ds_read_b128 v[208:211], v226
    ds_read_b64_tr_b16 a[16:17], v228 offset:16384
    ds_read_b64_tr_b16 a[18:19], v228 offset:16896
    v_mfma_f32_32x32x16_bf16 v[16:31], v[212:215], a[4:7], v[16:31]
    ds_read_b64_tr_b16 a[20:21], v229 offset:16384
    ds_read_b64_tr_b16 a[22:23], v229 offset:16896
    ds_read_b64_tr_b16 a[24:25], v228 offset:20480
    v_mfma_f32_32x32x16_bf16 v[32:47], v[212:215], a[8:11], v[32:47]
    ds_read_b64_tr_b16 a[26:27], v228 offset:20992
    ds_read_b64_tr_b16 a[28:29], v229 offset:20480
    ds_read_b64_tr_b16 a[30:31], v229 offset:20992
    s_add_u32 m0, s72, 0
    s_add_u32 s78, s96, 2
    s_and_b32 s78, s78, 3
    s_lshl_b32 s78, s78, 7
    s_add_u32 s78, s78, s97
    s_lshl_b32 s91, s99, 18
    s_add_u32 s78, s78, s91
    buffer_load_dwordx4 v216, s[48:51], s78 offen lds
    v_mfma_f32_32x32x16_bf16 v[48:63], v[212:215], a[12:15], v[48:63]
    buffer_load_dwordx4 v217, s[48:51], s78 offen offset:1024 lds
    s_waitcnt lgkmcnt(6)
    v_mfma_f32_32x32x16_bf16 v[0:15], v[208:211], a[16:19], v[0:15]
    ds_read_b128 v[212:215], v227
    ds_read_b64_tr_b16 a[32:33], v228 offset:18432
    ds_read_b64_tr_b16 a[34:35], v228 offset:18944
    s_waitcnt lgkmcnt(7)
    v_mfma_f32_32x32x16_bf16 v[16:31], v[208:211], a[20:23], v[16:31]
    ds_read_b64_tr_b16 a[36:37], v229 offset:18432
    ds_read_b64_tr_b16 a[38:39], v229 offset:18944
    ds_read_b64_tr_b16 a[40:41], v228 offset:22528
    s_add_u32 m0, s72, 0
    s_nop 0
    buffer_load_dwordx4 v218, s[48:51], s78 offen offset:2048 lds
    s_waitcnt lgkmcnt(8)
    v_mfma_f32_32x32x16_bf16 v[32:47], v[208:211], a[24:27], v[32:47]
    ds_read_b64_tr_b16 a[42:43], v228 offset:23040
    ds_read_b64_tr_b16 a[44:45], v229 offset:22528
    ds_read_b64_tr_b16 a[46:47], v229 offset:23040
    buffer_load_dwordx4 v219, s[48:51], s78 offen offset:3072 lds
    s_waitcnt lgkmcnt(9)
    v_mfma_f32_32x32x16_bf16 v[48:63], v[208:211], a[28:31], v[48:63]
    v_add_u32 v224, 114688, v220
    v_add_u32 v225, 114688, v221
    v_add_u32 v226, 114688, v222
    v_add_u32 v227, 114688, v223
    s_waitcnt vmcnt(22)
    s_waitcnt vmcnt(18)
    s_waitcnt vmcnt(13)
    s_waitcnt lgkmcnt(0)
    s_barrier
    s_cmp_lg_u32 s4, 0
    s_cbranch_scc1 L_nosig
    s_mov_b64 exec, 1
    buffer_store_dwordx2 v[250:251], v242, s[56:59], s84 offen sc1
    s_mov_b64 exec, -1
L_nosig:
    s_cmp_eq_u32 s81, 1
    s_cbranch_scc1 L_idle
    v_mfma_f32_32x32x16_bf16 v[0:15], v[212:215], a[32:35], v[0:15]
    ds_read_b128 v[208:211], v224
    ds_read_b64_tr_b16 a[48:49], v228 offset:32768
    ds_read_b64_tr_b16 a[50:51], v228 offset:33280
    v_mfma_f32_32x32x16_bf16 v[16:31], v[212:215], a[36:39], v[16:31]
    ds_read_b64_tr_b16 a[52:53], v229 offset:32768
    ds_read_b64_tr_b16 a[54:55], v229 offset:33280
    ds_read_b64_tr_b16 a[56:57], v228 offset:36864
    v_mfma_f32_32x32x16_bf16 v[32:47], v[212:215], a[40:43], v[32:47]
    ds_read_b64_tr_b16 a[58:59], v228 offset:37376
    ds_read_b64_tr_b16 a[60:61], v229 offset:36864
    ds_read_b64_tr_b16 a[62:63], v229 offset:37376
    s_add_u32 m0, s72, 16384
    s_add_u32 s77, s96, 3
    s_and_b32 s77, s77, 3
    s_lshl_b32 s77, s77, 7
    s_add_u32 s77, s77, s97
    s_lshl_b32 s91, s99, 18
    s_add_u32 s77, s77, s91
    buffer_load_dwordx4 v216, s[48:51], s77 offen lds
    v_mfma_f32_32x32x16_bf16 v[48:63], v[212:215], a[44:47], v[48:63]
    buffer_load_dwordx4 v217, s[48:51], s77 offen offset:1024 lds
    s_waitcnt lgkmcnt(6)
    v_mfma_f32_32x32x16_bf16 v[0:15], v[208:211], a[48:51], v[0:15]
    ds_read_b128 v[212:215], v225
    ds_read_b64_tr_b16 a[64:65], v228 offset:34816
    ds_read_b64_tr_b16 a[66:67], v228 offset:35328
    s_waitcnt lgkmcnt(7)
    v_mfma_f32_32x32x16_bf16 v[16:31], v[208:211], a[52:55], v[16:31]
    ds_read_b64_tr_b16 a[68:69], v229 offset:34816
    ds_read_b64_tr_b16 a[70:71], v229 offset:35328
    ds_read_b64_tr_b16 a[72:73], v228 offset:38912
    s_add_u32 m0, s72, 16384
    s_nop 0
    buffer_load_dwordx4 v218, s[48:51], s77 offen offset:2048 lds
    s_waitcnt lgkmcnt(8)
    v_mfma_f32_32x32x16_bf16 v[32:47], v[208:211], a[56:59], v[32:47]
    ds_read_b64_tr_b16 a[74:75], v228 offset:39424
    ds_read_b64_tr_b16 a[76:77], v229 offset:38912
    ds_read_b64_tr_b16 a[78:79], v229 offset:39424
    buffer_load_dwordx4 v219, s[48:51], s77 offen offset:3072 lds
    s_waitcnt lgkmcnt(9)
    v_mfma_f32_32x32x16_bf16 v[48:63], v[208:211], a[60:63], v[48:63]
    v_add_u32 v228, 49152, v228
    v_add_u32 v229, 49152, v229
    s_waitcnt vmcnt(16)
    s_waitcnt lgkmcnt(0)
    s_barrier
    v_mfma_f32_32x32x16_bf16 v[0:15], v[212:215], a[64:67], v[0:15]
    ds_read_b128 v[208:211], v226
    ds_read_b64_tr_b16 a[80:81], v228 offset:0
    ds_read_b64_tr_b16 a[82:83], v228 offset:512
    v_mfma_f32_32x32x16_bf16 v[16:31], v[212:215], a[68:71], v[16:31]
    ds_read_b64_tr_b16 a[84:85], v229 offset:0
    ds_read_b64_tr_b16 a[86:87], v229 offset:512
    ds_read_b64_tr_b16 a[88:89], v228 offset:4096
    v_mfma_f32_32x32x16_bf16 v[32:47], v[212:215], a[72:75], v[32:47]
    ds_read_b64_tr_b16 a[90:91], v228 offset:4608
    ds_read_b64_tr_b16 a[92:93], v229 offset:4096
    ds_read_b64_tr_b16 a[94:95], v229 offset:4608
    s_add_u32 m0, s72, 131072
    s_add_u32 s78, s96, 0
    s_and_b32 s78, s78, 3
    s_lshl_b32 s78, s78, 7
    s_add_u32 s78, s78, s97
    s_lshl_b32 s91, s100, 18
    s_add_u32 s78, s78, s91
    buffer_load_dwordx4 v216, s[48:51], s78 offen lds
    v_mfma_f32_32x32x16_bf16 v[48:63], v[212:215], a[76:79], v[48:63]
    buffer_load_dwordx4 v217, s[48:51], s78 offen offset:1024 lds
    s_waitcnt lgkmcnt(6)
    v_mfma_f32_32x32x16_bf16 v[0:15], v[208:211], a[80:83], v[0:15]
    ds_read_b128 v[212:215], v227
    ds_read_b64_tr_b16 a[96:97], v228 offset:2048
    ds_read_b64_tr_b16 a[98:99], v228 offset:2560
    s_waitcnt lgkmcnt(7)
    v_mfma_f32_32x32x16_bf16 v[16:31], v[208:211], a[84:87], v[16:31]
    ds_read_b64_tr_b16 a[100:101], v229 offset:2048
    ds_read_b64_tr_b16 a[102:103], v229 offset:2560
    ds_read_b64_tr_b16 a[104:105], v228 offset:6144
    s_add_u32 m0, s72, 131072
    s_nop 0
    buffer_load_dwordx4 v218, s[48:51], s78 offen offset:2048 lds
    s_waitcnt lgkmcnt(8)
    v_mfma_f32_32x32x16_bf16 v[32:47], v[208:211], a[88:91], v[32:47]
    ds_read_b64_tr_b16 a[106:107], v228 offset:6656
    ds_read_b64_tr_b16 a[108:109], v229 offset:6144
    ds_read_b64_tr_b16 a[110:111], v229 offset:6656
    buffer_load_dwordx4 v219, s[48:51], s78 offen offset:3072 lds
    s_waitcnt lgkmcnt(9)
    v_mfma_f32_32x32x16_bf16 v[48:63], v[208:211], a[92:95], v[48:63]
    v_add_u32 v224, 65536, v220
    v_add_u32 v225, 65536, v221
    v_add_u32 v226, 65536, v222
    v_add_u32 v227, 65536, v223
    s_waitcnt vmcnt(16)
    s_waitcnt lgkmcnt(0)
    s_barrier
    v_mfma_f32_32x32x16_bf16 v[0:15], v[212:215], a[96:99], v[0:15]
    ds_read_b128 v[208:211], v224
    v_mfma_f32_32x32x16_bf16 v[16:31], v[212:215], a[100:103], v[16:31]
    v_mfma_f32_32x32x16_bf16 v[32:47], v[212:215], a[104:107], v[32:47]
    v_mfma_f32_32x32x16_bf16 v[48:63], v[212:215], a[108:111], v[48:63]
    s_nop 7
    v_cvt_pk_bf16_f32 v64, v0, v1
    v_cvt_pk_bf16_f32 v65, v2, v3
    v_cvt_pk_bf16_f32 v66, v4, v5
    v_cvt_pk_bf16_f32 v67, v6, v7
    v_cvt_pk_bf16_f32 v68, v8, v9
    v_cvt_pk_bf16_f32 v69, v10, v11
    v_cvt_pk_bf16_f32 v70, v12, v13
    v_cvt_pk_bf16_f32 v71, v14, v15
    s_waitcnt lgkmcnt(0)
    v_mfma_f32_32x32x16_bf16 v[0:15], v[208:211], a[112:115], 0
    ds_read_b128 v[212:215], v225
    v_cvt_pk_bf16_f32 v72, v16, v17
    v_cvt_pk_bf16_f32 v73, v18, v19
    v_cvt_pk_bf16_f32 v74, v20, v21
    v_cvt_pk_bf16_f32 v75, v22, v23
    v_cvt_pk_bf16_f32 v76, v24, v25
    v_cvt_pk_bf16_f32 v77, v26, v27
    v_cvt_pk_bf16_f32 v78, v28, v29
    v_cvt_pk_bf16_f32 v79, v30, v31
    v_mfma_f32_32x32x16_bf16 v[16:31], v[208:211], a[116:119], 0
    v_cvt_pk_bf16_f32 v80, v32, v33
    v_cvt_pk_bf16_f32 v81, v34, v35
    v_cvt_pk_bf16_f32 v82, v36, v37
    v_cvt_pk_bf16_f32 v83, v38, v39
    v_cvt_pk_bf16_f32 v84, v40, v41
    v_cvt_pk_bf16_f32 v85, v42, v43
    v_cvt_pk_bf16_f32 v86, v44, v45
    v_cvt_pk_bf16_f32 v87, v46, v47
    v_mfma_f32_32x32x16_bf16 v[32:47], v[208:211], a[120:123], 0
    v_cvt_pk_bf16_f32 v88, v48, v49
    v_cvt_pk_bf16_f32 v89, v50, v51
    v_cvt_pk_bf16_f32 v90, v52, v53
    v_cvt_pk_bf16_f32 v91, v54, v55
    v_cvt_pk_bf16_f32 v92, v56, v57
    v_cvt_pk_bf16_f32 v93, v58, v59
    v_cvt_pk_bf16_f32 v94, v60, v61
    v_cvt_pk_bf16_f32 v95, v62, v63
    s_add_u32 m0, s72, 32768
    s_add_u32 s77, s96, 1
    s_and_b32 s77, s77, 3
    s_lshl_b32 s77, s77, 7
    s_add_u32 s77, s77, s97
    s_lshl_b32 s91, s100, 18
    s_add_u32 s77, s77, s91
    buffer_load_dwordx4 v216, s[48:51], s77 offen lds
    buffer_load_dwordx4 v217, s[48:51], s77 offen offset:1024 lds
    v_mfma_f32_32x32x16_bf16 v[48:63], v[208:211], a[124:127], 0
    s_add_u32 m0, s72, 32768
    s_nop 0
    buffer_load_dwordx4 v218, s[48:51], s77 offen offset:2048 lds
    buffer_load_dwordx4 v219, s[48:51], s77 offen offset:3072 lds
    s_waitcnt lgkmcnt(0)
    v_mfma_f32_32x32x16_bf16 v[0:15], v[212:215], a[128:131], v[0:15]
    ds_read_b128 v[208:211], v226
    v_mfma_f32_32x32x16_bf16 v[16:31], v[212:215], a[132:135], v[16:31]
    v_mfma_f32_32x32x16_bf16 v[32:47], v[212:215], a[136:139], v[32:47]
    v_mfma_f32_32x32x16_bf16 v[48:63], v[212:215], a[140:143], v[48:63]
    s_add_u32 m0, s72, 98304
    s_add_u32 s78, s96, 2
    s_and_b32 s78, s78, 3
    s_lshl_b32 s78, s78, 7
    s_add_u32 s78, s78, s97
    s_lshl_b32 s91, s100, 18
    s_add_u32 s78, s78, s91
    buffer_load_dwordx4 v216, s[48:51], s78 offen lds
    s_waitcnt lgkmcnt(0)
    v_mfma_f32_32x32x16_bf16 v[0:15], v[208:211], a[144:147], v[0:15]
    ds_read_b128 v[212:215], v227
    buffer_load_dwordx4 v217, s[48:51], s78 offen offset:1024 lds
    v_mfma_f32_32x32x16_bf16 v[16:31], v[208:211], a[148:151], v[16:31]
    s_add_u32 m0, s72, 98304
    s_nop 0
    buffer_load_dwordx4 v218, s[48:51], s78 offen offset:2048 lds
    v_mfma_f32_32x32x16_bf16 v[32:47], v[208:211], a[152:155], v[32:47]
    buffer_load_dwordx4 v219, s[48:51], s78 offen offset:3072 lds
    v_mfma_f32_32x32x16_bf16 v[48:63], v[208:211], a[156:159], v[48:63]
    v_add_u32 v224, 81920, v220
    v_add_u32 v225, 81920, v221
    v_add_u32 v226, 81920, v222
    v_add_u32 v227, 81920, v223
    s_waitcnt vmcnt(20)
    s_waitcnt lgkmcnt(0)
    v_mfma_f32_32x32x16_bf16 v[0:15], v[212:215], a[160:163], v[0:15]
    ds_read_b128 v[208:211], v224
    v_mfma_f32_32x32x16_bf16 v[16:31], v[212:215], a[164:167], v[16:31]
    v_mfma_f32_32x32x16_bf16 v[32:47], v[212:215], a[168:171], v[32:47]
    v_mfma_f32_32x32x16_bf16 v[48:63], v[212:215], a[172:175], v[48:63]
    s_add_u32 m0, s72, 114688
    s_add_u32 s77, s96, 3
    s_and_b32 s77, s77, 3
    s_lshl_b32 s77, s77, 7
    s_add_u32 s77, s77, s97
    s_lshl_b32 s91, s100, 18
    s_add_u32 s77, s77, s91
    buffer_load_dwordx4 v216, s[48:51], s77 offen lds
    s_waitcnt lgkmcnt(0)
    v_mfma_f32_32x32x16_bf16 v[0:15], v[208:211], a[176:179], v[0:15]
    ds_read_b128 v[212:215], v225
    buffer_load_dwordx4 v217, s[48:51], s77 offen offset:1024 lds
    v_mfma_f32_32x32x16_bf16 v[16:31], v[208:211], a[180:183], v[16:31]
    s_add_u32 m0, s72, 114688
    s_nop 0
    buffer_load_dwordx4 v218, s[48:51], s77 offen offset:2048 lds
    v_mfma_f32_32x32x16_bf16 v[32:47], v[208:211], a[184:187], v[32:47]
    buffer_load_dwordx4 v219, s[48:51], s77 offen offset:3072 lds
    v_mfma_f32_32x32x16_bf16 v[48:63], v[208:211], a[188:191], v[48:63]
    buffer_load_dwordx2 v[244:245], v243, s[56:59], 0 offen sc1
    s_waitcnt lgkmcnt(0)
    v_mfma_f32_32x32x16_bf16 v[0:15], v[212:215], a[192:195], v[0:15]
    ds_read_b128 v[208:211], v226
    v_mfma_f32_32x32x16_bf16 v[16:31], v[212:215], a[196:199], v[16:31]
    v_mfma_f32_32x32x16_bf16 v[32:47], v[212:215], a[200:203], v[32:47]
    v_mfma_f32_32x32x16_bf16 v[48:63], v[212:215], a[204:207], v[48:63]
    s_add_u32 m0, s72, 65536
    s_add_u32 s78, s96, 0
    s_and_b32 s78, s78, 3
    s_lshl_b32 s78, s78, 7
    s_add_u32 s78, s78, s97
    s_lshl_b32 s91, s101, 18
    s_add_u32 s78, s78, s91
    buffer_load_dwordx4 v216, s[48:51], s78 offen lds
    s_waitcnt lgkmcnt(0)
    v_mfma_f32_32x32x16_bf16 v[0:15], v[208:211], a[208:211], v[0:15]
    ds_read_b128 v[212:215], v227
    buffer_load_dwordx4 v217, s[48:51], s78 offen offset:1024 lds
    v_mfma_f32_32x32x16_bf16 v[16:31], v[208:211], a[212:215], v[16:31]
    s_add_u32 m0, s72, 65536
    s_nop 0
    buffer_load_dwordx4 v218, s[48:51], s78 offen offset:2048 lds
    v_mfma_f32_32x32x16_bf16 v[32:47], v[208:211], a[216:219], v[32:47]
    buffer_load_dwordx4 v219, s[48:51], s78 offen offset:3072 lds
    v_mfma_f32_32x32x16_bf16 v[48:63], v[208:211], a[220:223], v[48:63]
    v_add_u32 v224, 0, v220
    v_add_u32 v225, 0, v221
    v_add_u32 v226, 0, v222
    v_add_u32 v227, 0, v223
    s_waitcnt vmcnt(25)
    s_waitcnt lgkmcnt(0)
    v_mfma_f32_32x32x16_bf16 v[0:15], v[212:215], a[224:227], v[0:15]
    ds_read_b128 v[208:211], v224
    v_mfma_f32_32x32x16_bf16 v[16:31], v[212:215], a[228:231], v[16:31]
    v_mfma_f32_32x32x16_bf16 v[32:47], v[212:215], a[232:235], v[32:47]
    v_mfma_f32_32x32x16_bf16 v[48:63], v[212:215], a[236:239], v[48:63]
    s_add_u32 m0, s72, 81920
    s_add_u32 s77, s96, 1
    s_and_b32 s77, s77, 3
    s_lshl_b32 s77, s77, 7
    s_add_u32 s77, s77, s97
    s_lshl_b32 s91, s101, 18
    s_add_u32 s77, s77, s91
    buffer_load_dwordx4 v216, s[48:51], s77 offen lds
    s_waitcnt lgkmcnt(0)
    v_mfma_f32_32x32x16_bf16 v[0:15], v[208:211], a[240:243], v[0:15]
    ds_read_b128 v[212:215], v225
    buffer_load_dwordx4 v217, s[48:51], s77 offen offset:1024 lds
    v_mfma_f32_32x32x16_bf16 v[16:31], v[208:211], a[244:247], v[16:31]
    s_add_u32 m0, s72, 81920
    s_nop 0
    buffer_load_dwordx4 v218, s[48:51], s77 offen offset:2048 lds
    v_mfma_f32_32x32x16_bf16 v[32:47], v[208:211], a[248:251], v[32:47]
    buffer_load_dwordx4 v219, s[48:51], s77 offen offset:3072 lds
    v_mfma_f32_32x32x16_bf16 v[48:63], v[208:211], a[252:255], v[48:63]
    s_waitcnt vmcnt(8)
    v_xor_b32 v248, v244, v250
    v_xor_b32 v249, v245, v251
    v_or_b32 v248, v248, v249
    v_cmp_eq_u32 vcc, 0, v248
    s_nop 3
    s_cmp_eq_u64 vcc, -1
    s_cbranch_scc0 L_slow1
L_back1:
    s_waitcnt lgkmcnt(0)
    v_mfma_f32_32x32x16_bf16 v[0:15], v[212:215], a[0:3], v[0:15]
    ds_read_b128 v[208:211], v226
    v_mfma_f32_32x32x16_bf16 v[16:31], v[212:215], a[4:7], v[16:31]
    v_mfma_f32_32x32x16_bf16 v[32:47], v[212:215], a[8:11], v[32:47]
    v_mfma_f32_32x32x16_bf16 v[48:63], v[212:215], a[12:15], v[48:63]
    s_lshl_b32 s91, s98, 16
    s_add_u32 s91, s91, s83
    buffer_load_dwordx4 v[128:131], v234, s[56:59], s91 offen sc1
    s_waitcnt lgkmcnt(0)
    v_mfma_f32_32x32x16_bf16 v[0:15], v[208:211], a[16:19], v[0:15]
    ds_read_b128 v[212:215], v227
    buffer_load_dwordx4 v[132:135], v234, s[56:59], s91 offen offset:1024 sc1
    v_mfma_f32_32x32x16_bf16 v[16:31], v[208:211], a[20:23], v[16:31]
    buffer_load_dwordx4 v[136:139], v234, s[56:59], s91 offen offset:2048 sc1
    v_mfma_f32_32x32x16_bf16 v[32:47], v[208:211], a[24:27], v[32:47]
    buffer_load_dwordx4 v[140:143], v234, s[56:59], s91 offen offset:3072 sc1
    v_mfma_f32_32x32x16_bf16 v[48:63], v[208:211], a[28:31], v[48:63]
    v_add_u32 v224, 16384, v220
    v_add_u32 v225, 16384, v221
    v_add_u32 v226, 16384, v222
    v_add_u32 v227, 16384, v223
    s_waitcnt lgkmcnt(0)
    v_mfma_f32_32x32x16_bf16 v[0:15], v[212:215], a[32:35], v[0:15]
    ds_read_b128 v[208:211], v224
    v_mfma_f32_32x32x16_bf16 v[16:31], v[212:215], a[36:39], v[16:31]
    v_mfma_f32_32x32x16_bf16 v[32:47], v[212:215], a[40:43], v[32:47]
    v_mfma_f32_32x32x16_bf16 v[48:63], v[212:215], a[44:47], v[48:63]
    s_add_u32 m0, s72, 0
    s_add_u32 s78, s96, 2
    s_and_b32 s78, s78, 3
    s_lshl_b32 s78, s78, 7
    s_add_u32 s78, s78, s97
    s_lshl_b32 s91, s101, 18
    s_add_u32 s78, s78, s91
    buffer_load_dwordx4 v216, s[48:51], s78 offen lds
    buffer_load_dwordx4 v217, s[48:51], s78 offen offset:1024 lds
    s_waitcnt lgkmcnt(0)
    v_mfma_f32_32x32x16_bf16 v[0:15], v[208:211], a[48:51], v[0:15]
    ds_read_b128 v[212:215], v225
    s_add_u32 m0, s72, 0
    s_nop 0
    buffer_load_dwordx4 v218, s[48:51], s78 offen offset:2048 lds
    buffer_load_dwordx4 v219, s[48:51], s78 offen offset:3072 lds
    v_mfma_f32_32x32x16_bf16 v[16:31], v[208:211], a[52:55], v[16:31]
    s_lshl_b32 s91, s99, 16
    s_add_u32 s91, s91, s83
    buffer_load_dwordx4 v[144:147], v234, s[56:59], s91 offen sc1
    v_mfma_f32_32x32x16_bf16 v[32:47], v[208:211], a[56:59], v[32:47]
    buffer_load_dwordx4 v[148:151], v234, s[56:59], s91 offen offset:1024 sc1
    buffer_load_dwordx4 v[152:155], v234, s[56:59], s91 offen offset:2048 sc1
    v_mfma_f32_32x32x16_bf16 v[48:63], v[208:211], a[60:63], v[48:63]
    buffer_load_dwordx4 v[156:159], v234, s[56:59], s91 offen offset:3072 sc1
    s_waitcnt lgkmcnt(0)
    v_mfma_f32_32x32x16_bf16 v[0:15], v[212:215], a[64:67], v[0:15]
    ds_read_b128 v[208:211], v226
    v_mfma_f32_32x32x16_bf16 v[16:31], v[212:215], a[68:71], v[16:31]
    v_mfma_f32_32x32x16_bf16 v[32:47], v[212:215], a[72:75], v[32:47]
    v_mfma_f32_32x32x16_bf16 v[48:63], v[212:215], a[76:79], v[48:63]
    s_waitcnt lgkmcnt(0)
    v_mfma_f32_32x32x16_bf16 v[0:15], v[208:211], a[80:83], v[0:15]
    ds_read_b128 v[212:215], v227
    v_mfma_f32_32x32x16_bf16 v[16:31], v[208:211], a[84:87], v[16:31]
    v_mfma_f32_32x32x16_bf16 v[32:47], v[208:211], a[88:91], v[32:47]
    v_mfma_f32_32x32x16_bf16 v[48:63], v[208:211], a[92:95], v[48:63]
    v_add_u32 v224, 131072, v220
    v_add_u32 v225, 131072, v221
    v_add_u32 v226, 131072, v222
    v_add_u32 v227, 131072, v223
    s_waitcnt lgkmcnt(0)
    v_mfma_f32_32x32x16_bf16 v[0:15], v[212:215], a[96:99], v[0:15]
    ds_read_b128 v[208:211], v224
    v_mfma_f32_32x32x16_bf16 v[16:31], v[212:215], a[100:103], v[16:31]
    v_mfma_f32_32x32x16_bf16 v[32:47], v[212:215], a[104:107], v[32:47]
    v_mfma_f32_32x32x16_bf16 v[48:63], v[212:215], a[108:111], v[48:63]
    s_nop 7
    v_cvt_pk_bf16_f32 v96, v0, v1
    v_cvt_pk_bf16_f32 v97, v2, v3
    v_cvt_pk_bf16_f32 v98, v4, v5
    v_cvt_pk_bf16_f32 v99, v6, v7
    v_cvt_pk_bf16_f32 v100, v8, v9
    v_cvt_pk_bf16_f32 v101, v10, v11
    v_cvt_pk_bf16_f32 v102, v12, v13
    v_cvt_pk_bf16_f32 v103, v14, v15
    s_waitcnt lgkmcnt(0)
    v_mfma_f32_32x32x16_bf16 v[0:15], v[208:211], a[112:115], 0
    ds_read_b128 v[212:215], v225
    v_cvt_pk_bf16_f32 v104, v16, v17
    v_cvt_pk_bf16_f32 v105, v18, v19
    v_cvt_pk_bf16_f32 v106, v20, v21
    v_cvt_pk_bf16_f32 v107, v22, v23
    v_cvt_pk_bf16_f32 v108, v24, v25
    v_cvt_pk_bf16_f32 v109, v26, v27
    v_cvt_pk_bf16_f32 v110, v28, v29
    v_cvt_pk_bf16_f32 v111, v30, v31
    v_mfma_f32_32x32x16_bf16 v[16:31], v[208:211], a[116:119], 0
    v_cvt_pk_bf16_f32 v112, v32, v33
    v_cvt_pk_bf16_f32 v113, v34, v35
    v_cvt_pk_bf16_f32 v114, v36, v37
    v_cvt_pk_bf16_f32 v115, v38, v39
    v_cvt_pk_bf16_f32 v116, v40, v41
    v_cvt_pk_bf16_f32 v117, v42, v43
    v_cvt_pk_bf16_f32 v118, v44, v45
    v_cvt_pk_bf16_f32 v119, v46, v47
    v_mfma_f32_32x32x16_bf16 v[32:47], v[208:211], a[120:123], 0
    v_cvt_pk_bf16_f32 v120, v48, v49
    v_cvt_pk_bf16_f32 v121, v50, v51
    v_cvt_pk_bf16_f32 v122, v52, v53
    v_cvt_pk_bf16_f32 v123, v54, v55
    v_cvt_pk_bf16_f32 v124, v56, v57
    v_cvt_pk_bf16_f32 v125, v58, v59
    v_cvt_pk_bf16_f32 v126, v60, v61
    v_cvt_pk_bf16_f32 v127, v62, v63
    s_add_u32 m0, s72, 16384
    s_add_u32 s77, s96, 3
    s_and_b32 s77, s77, 3
    s_lshl_b32 s77, s77, 7
    s_add_u32 s77, s77, s97
    s_lshl_b32 s91, s101, 18
    s_add_u32 s77, s77, s91
    buffer_load_dwordx4 v216, s[48:51], s77 offen lds
    buffer_load_dwordx4 v217, s[48:51], s77 offen offset:1024 lds
    v_mfma_f32_32x32x16_bf16 v[48:63], v[208:211], a[124:127], 0
    s_add_u32 m0, s72, 16384
    s_nop 0
    buffer_load_dwordx4 v218, s[48:51], s77 offen offset:2048 lds
    buffer_load_dwordx4 v219, s[48:51], s77 offen offset:3072 lds
    s_waitcnt lgkmcnt(0)
    v_mfma_f32_32x32x16_bf16 v[0:15], v[212:215], a[128:131], v[0:15]
    ds_read_b128 v[208:211], v226
    v_mfma_f32_32x32x16_bf16 v[16:31], v[212:215], a[132:135], v[16:31]
    v_mfma_f32_32x32x16_bf16 v[32:47], v[212:215], a[136:139], v[32:47]
    v_mfma_f32_32x32x16_bf16 v[48:63], v[212:215], a[140:143], v[48:63]
    s_waitcnt lgkmcnt(0)
    v_mfma_f32_32x32x16_bf16 v[0:15], v[208:211], a[144:147], v[0:15]
    ds_read_b128 v[212:215], v227
    v_mfma_f32_32x32x16_bf16 v[16:31], v[208:211], a[148:151], v[16:31]
    v_mfma_f32_32x32x16_bf16 v[32:47], v[208:211], a[152:155], v[32:47]
    v_mfma_f32_32x32x16_bf16 v[48:63], v[208:211], a[156:159], v[48:63]
    v_add_u32 v224, 32768, v220
    v_add_u32 v225, 32768, v221
    v_add_u32 v226, 32768, v222
    v_add_u32 v227, 32768, v223
    s_waitcnt vmcnt(15)
    v_mfma_f32_32x32x16_bf16 v[176:191], v[72:75], v[128:131], 0
    s_waitcnt vmcnt(14)
    v_mfma_f32_32x32x16_bf16 v[176:191], v[76:79], v[132:135], v[176:191]
    s_waitcnt vmcnt(13)
    v_mfma_f32_32x32x16_bf16 v[176:191], v[88:91], v[136:139], v[176:191]
    s_waitcnt vmcnt(12)
    v_mfma_f32_32x32x16_bf16 v[176:191], v[92:95], v[140:143], v[176:191]
    v_mfma_f32_32x32x16_bf16 v[160:175], v[64:67], v[128:131], 0
    v_mfma_f32_32x32x16_bf16 v[160:175], v[68:71], v[132:135], v[160:175]
    s_nop 9
    ds_write_b128 v236, v[176:179] offset:0
    ds_write_b128 v236, v[180:183] offset:1024
    v_mfma_f32_32x32x16_bf16 v[160:175], v[80:83], v[136:139], v[160:175]
    ds_write_b128 v236, v[184:187] offset:2048
    v_mfma_f32_32x32x16_bf16 v[160:175], v[84:87], v[140:143], v[160:175]
    ds_write_b128 v236, v[188:191] offset:3072
    s_waitcnt lgkmcnt(0)
    s_barrier
    v_mfma_f32_32x32x16_bf16 v[0:15], v[212:215], a[160:163], v[0:15]
    ds_read_b128 v[208:211], v224
    ds_read_b128 v[192:195], v238 offset:0
    ds_read_b128 v[196:199], v238 offset:1024
    v_mfma_f32_32x32x16_bf16 v[16:31], v[212:215], a[164:167], v[16:31]
    ds_read_b128 v[200:203], v238 offset:2048
    ds_read_b128 v[204:207], v238 offset:3072
    v_mfma_f32_32x32x16_bf16 v[32:47], v[212:215], a[168:171], v[32:47]
    v_mfma_f32_32x32x16_bf16 v[48:63], v[212:215], a[172:175], v[48:63]
    s_waitcnt lgkmcnt(3)
    v_add_f32 v160, v160, v192
    v_add_f32 v161, v161, v193
    v_add_f32 v162, v162, v194
    v_add_f32 v163, v163, v195
    s_waitcnt lgkmcnt(2)
    v_add_f32 v164, v164, v196
    s_and_b32 s3, s2, 0xfffffffc
    s_or_b32 s3, s3, s100
    s_lshl_b32 s3, s3, 2
    s_add_u32 s3, s3, s4
    s_lshl_b32 s3, s3, 7
    s_add_u32 s3, s3, 6356992
    buffer_load_dwordx2 v[244:245], v242, s[56:59], s3 offen offset:64 sc1
    v_mfma_f32_32x32x16_bf16 v[0:15], v[208:211], a[176:179], v[0:15]
    ds_read_b128 v[212:215], v225
    v_add_f32 v165, v165, v197
    v_add_f32 v166, v166, v198
    v_add_f32 v167, v167, v199
    s_waitcnt lgkmcnt(2)
    v_add_f32 v168, v168, v200
    v_add_f32 v169, v169, v201
    s_lshl_b32 s91, s100, 16
    s_add_u32 s91, s91, s83
    buffer_load_dwordx4 v[128:131], v234, s[56:59], s91 offen sc1
    v_mfma_f32_32x32x16_bf16 v[16:31], v[208:211], a[180:183], v[16:31]
    v_add_f32 v170, v170, v202
    v_add_f32 v171, v171, v203
    s_waitcnt lgkmcnt(1)
    v_add_f32 v172, v172, v204
    v_add_f32 v173, v173, v205
    v_add_f32 v174, v174, v206
    buffer_load_dwordx4 v[132:135], v234, s[56:59], s91 offen offset:1024 sc1
    v_mfma_f32_32x32x16_bf16 v[32:47], v[208:211], a[184:187], v[32:47]
    v_add_f32 v175, v175, v207
    v_cvt_pk_bf16_f32 v160, v160, v161
    v_cvt_pk_bf16_f32 v161, v162, v163
    v_cvt_pk_bf16_f32 v162, v164, v165
    v_cvt_pk_bf16_f32 v163, v166, v167
    buffer_load_dwordx4 v[136:139], v234, s[56:59], s91 offen offset:2048 sc1
    v_mfma_f32_32x32x16_bf16 v[48:63], v[208:211], a[188:191], v[48:63]
    v_cvt_pk_bf16_f32 v164, v168, v169
    v_cvt_pk_bf16_f32 v165, v170, v171
    v_cvt_pk_bf16_f32 v166, v172, v173
    v_cvt_pk_bf16_f32 v167, v174, v175
    buffer_load_dwordx4 v[140:143], v234, s[56:59], s91 offen offset:3072 sc1
    s_waitcnt lgkmcnt(0)
    v_mfma_f32_32x32x16_bf16 v[0:15], v[212:215], a[192:195], v[0:15]
    ds_read_b128 v[208:211], v226
    v_mfma_f32_32x32x16_bf16 v[16:31], v[212:215], a[196:199], v[16:31]
    v_mfma_f32_32x32x16_bf16 v[32:47], v[212:215], a[200:203], v[32:47]
    v_mfma_f32_32x32x16_bf16 v[48:63], v[212:215], a[204:207], v[48:63]
    s_and_b32 s3, s2, 0xfffffffc
    s_or_b32 s3, s3, s98
    s_mul_i32 s3, s3, 12
    s_add_u32 s3, s3, 0
    s_add_u32 s3, s3, s4
    s_lshl_b32 s3, s3, 11
    s_add_u32 s3, s3, 8388608
    buffer_store_dwordx4 v[160:163], v234, s[56:59], s3 offen offset:0 sc1
    s_waitcnt lgkmcnt(0)
    v_mfma_f32_32x32x16_bf16 v[0:15], v[208:211], a[208:211], v[0:15]
    ds_read_b128 v[212:215], v227
    v_mfma_f32_32x32x16_bf16 v[16:31], v[208:211], a[212:215], v[16:31]
    buffer_store_dwordx4 v[164:167], v234, s[56:59], s3 offen offset:1024 sc1
    v_mfma_f32_32x32x16_bf16 v[32:47], v[208:211], a[216:219], v[32:47]
    v_mfma_f32_32x32x16_bf16 v[48:63], v[208:211], a[220:223], v[48:63]
    v_add_u32 v224, 98304, v220
    v_add_u32 v225, 98304, v221
    v_add_u32 v226, 98304, v222
    v_add_u32 v227, 98304, v223
    s_waitcnt lgkmcnt(0)
    v_mfma_f32_32x32x16_bf16 v[0:15], v[212:215], a[224:227], v[0:15]
    ds_read_b128 v[208:211], v224
    v_mfma_f32_32x32x16_bf16 v[16:31], v[212:215], a[228:231], v[16:31]
    v_mfma_f32_32x32x16_bf16 v[32:47], v[212:215], a[232:235], v[32:47]
    v_mfma_f32_32x32x16_bf16 v[48:63], v[212:215], a[236:239], v[48:63]
    s_waitcnt lgkmcnt(0)
    v_mfma_f32_32x32x16_bf16 v[0:15], v[208:211], a[240:243], v[0:15]
    ds_read_b128 v[212:215], v225
    v_mfma_f32_32x32x16_bf16 v[16:31], v[208:211], a[244:247], v[16:31]
    v_mfma_f32_32x32x16_bf16 v[32:47], v[208:211], a[248:251], v[32:47]
    v_mfma_f32_32x32x16_bf16 v[48:63], v[208:211], a[252:255], v[48:63]
    s_waitcnt vmcnt(14)
    v_mfma_f32_32x32x16_bf16 v[176:191], v[104:107], v[144:147], 0
    s_waitcnt vmcnt(13)
    v_mfma_f32_32x32x16_bf16 v[176:191], v[108:111], v[148:151], v[176:191]
    s_waitcnt vmcnt(12)
    v_mfma_f32_32x32x16_bf16 v[176:191], v[120:123], v[152:155], v[176:191]
    s_waitcnt vmcnt(11)
    v_mfma_f32_32x32x16_bf16 v[176:191], v[124:127], v[156:159], v[176:191]
    v_mfma_f32_32x32x16_bf16 v[160:175], v[96:99], v[144:147], 0
    v_mfma_f32_32x32x16_bf16 v[160:175], v[100:103], v[148:151], v[160:175]
    v_subrev_u32 v249, 98304, v236
    s_nop 8
    ds_write_b128 v249, v[176:179] offset:0
    v_mfma_f32_32x32x16_bf16 v[160:175], v[112:115], v[152:155], v[160:175]
    ds_write_b128 v249, v[180:183] offset:1024
    ds_write_b128 v249, v[184:187] offset:2048
    v_mfma_f32_32x32x16_bf16 v[160:175], v[116:119], v[156:159], v[160:175]
    ds_write_b128 v249, v[188:191] offset:3072
    s_waitcnt lgkmcnt(0)
    s_barrier
    v_mfma_f32_32x32x16_bf16 v[0:15], v[212:215], a[0:3], v[0:15]
    ds_read_b128 v[208:211], v226
    v_subrev_u32 v249, 98304, v238
    ds_read_b128 v[192:195], v249 offset:0
    ds_read_b128 v[196:199], v249 offset:1024
    v_mfma_f32_32x32x16_bf16 v[16:31], v[212:215], a[4:7], v[16:31]
    ds_read_b128 v[200:203], v249 offset:2048
    ds_read_b128 v[204:207], v249 offset:3072
    v_mfma_f32_32x32x16_bf16 v[32:47], v[212:215], a[8:11], v[32:47]
    v_mfma_f32_32x32x16_bf16 v[48:63], v[212:215], a[12:15], v[48:63]
    s_waitcnt lgkmcnt(3)
    v_add_f32 v160, v160, v192
    v_add_f32 v161, v161, v193
    v_add_f32 v162, v162, v194
    v_add_f32 v163, v163, v195
    s_waitcnt lgkmcnt(2)
    v_add_f32 v164, v164, v196
    s_lshl_b32 s91, s101, 16
    s_add_u32 s91, s91, s83
    buffer_load_dwordx4 v[144:147], v234, s[56:59], s91 offen sc1
    v_mfma_f32_32x32x16_bf16 v[0:15], v[208:211], a[16:19], v[0:15]
    ds_read_b128 v[212:215], v227
    v_add_f32 v165, v165, v197
    v_add_f32 v166, v166, v198
    v_add_f32 v167, v167, v199
    s_waitcnt lgkmcnt(2)
    v_add_f32 v168, v168, v200
    v_add_f32 v169, v169, v201
    buffer_load_dwordx4 v[148:151], v234, s[56:59], s91 offen offset:1024 sc1
    v_mfma_f32_32x32x16_bf16 v[16:31], v[208:211], a[20:23], v[16:31]
    v_add_f32 v170, v170, v202
    v_add_f32 v171, v171, v203
    s_waitcnt lgkmcnt(1)
    v_add_f32 v172, v172, v204
    v_add_f32 v173, v173, v205
    v_add_f32 v174, v174, v206
    buffer_load_dwordx4 v[152:155], v234, s[56:59], s91 offen offset:2048 sc1
    v_mfma_f32_32x32x16_bf16 v[32:47], v[208:211], a[24:27], v[32:47]
    v_add_f32 v175, v175, v207
    v_cvt_pk_bf16_f32 v160, v160, v161
    v_cvt_pk_bf16_f32 v161, v162, v163
    v_cvt_pk_bf16_f32 v162, v164, v165
    v_cvt_pk_bf16_f32 v163, v166, v167
    buffer_load_dwordx4 v[156:159], v234, s[56:59], s91 offen offset:3072 sc1
    v_mfma_f32_32x32x16_bf16 v[48:63], v[208:211], a[28:31], v[48:63]
    v_cvt_pk_bf16_f32 v164, v168, v169
    v_cvt_pk_bf16_f32 v165, v170, v171
    v_cvt_pk_bf16_f32 v166, v172, v173
    v_cvt_pk_bf16_f32 v167, v174, v175
    v_add_u32 v224, 114688, v220
    v_add_u32 v225, 114688, v221
    v_add_u32 v226, 114688, v222
    v_add_u32 v227, 114688, v223
    s_waitcnt vmcnt(10)
    v_xor_b32 v248, v244, v250
    v_xor_b32 v249, v245, v251
    v_or_b32 v248, v248, v249
    v_cmp_eq_u32 vcc, 0, v248
    s_nop 3
    s_cmp_eq_u64 vcc, -1
    s_cbranch_scc0 L_slow3
L_back3:
    s_waitcnt lgkmcnt(0)
    v_mfma_f32_32x32x16_bf16 v[0:15], v[212:215], a[32:35], v[0:15]
    ds_read_b128 v[208:211], v224
    v_mfma_f32_32x32x16_bf16 v[16:31], v[212:215], a[36:39], v[16:31]
    v_mfma_f32_32x32x16_bf16 v[32:47], v[212:215], a[40:43], v[32:47]
    v_mfma_f32_32x32x16_bf16 v[48:63], v[212:215], a[44:47], v[48:63]
    s_and_b32 s3, s2, 0xfffffffc
    s_or_b32 s3, s3, s99
    s_mul_i32 s3, s3, 12
    s_add_u32 s3, s3, 4
    s_add_u32 s3, s3, s4
    s_lshl_b32 s3, s3, 11
    s_add_u32 s3, s3, 8388608
    buffer_store_dwordx4 v[160:163], v234, s[56:59], s3 offen offset:0 sc1
    s_waitcnt lgkmcnt(0)
    v_mfma_f32_32x32x16_bf16 v[0:15], v[208:211], a[48:51], v[0:15]
    ds_read_b128 v[212:215], v225
    buffer_store_dwordx4 v[164:167], v234, s[56:59], s3 offen offset:1024 sc1
    v_mfma_f32_32x32x16_bf16 v[16:31], v[208:211], a[52:55], v[16:31]
    v_mfma_f32_32x32x16_bf16 v[32:47], v[208:211], a[56:59], v[32:47]
    s_waitcnt vmcnt(6)
    s_and_b32 s3, s2, 0xfffffffc
    s_or_b32 s3, s3, s98
    s_lshl_b32 s3, s3, 2
    s_add_u32 s3, s3, s4
    s_lshl_b32 s3, s3, 7
    s_add_u32 s3, s3, 6356992
    s_mov_b64 exec, 1
    buffer_store_dwordx2 v[250:251], v242, s[56:59], s3 offen sc1
    s_mov_b64 exec, -1
    v_mfma_f32_32x32x16_bf16 v[48:63], v[208:211], a[60:63], v[48:63]
    s_waitcnt lgkmcnt(0)
    v_mfma_f32_32x32x16_bf16 v[0:15], v[212:215], a[64:67], v[0:15]
    ds_read_b128 v[208:211], v226
    v_lshrrev_b32 v244, 4, v234
    v_bfe_u32 v245, v244, 2, 1
    v_lshrrev_b32 v246, 5, v244
    v_cmp_eq_u32 vcc, v245, v246
    v_mfma_f32_32x32x16_bf16 v[16:31], v[212:215], a[68:71], v[16:31]
    v_and_b32 v245, 1, v244
    v_lshlrev_b32 v245, 4, v245
    v_mov_b32 v246, 0x3f80
    v_lshlrev_b32 v246, v245, v246
    v_mfma_f32_32x32x16_bf16 v[32:47], v[212:215], a[72:75], v[32:47]
    v_cndmask_b32 v246, 0, v246, vcc
    v_bfe_u32 v245, v244, 1, 1
    v_bfe_u32 v247, v244, 3, 1
    v_lshl_add_u32 v245, v247, 1, v245
    v_mfma_f32_32x32x16_bf16 v[48:63], v[212:215], a[76:79], v[48:63]
    v_bfe_u32 v247, v244, 4, 1
    v_lshl_add_u32 v245, v247, 2, v245
    v_cmp_eq_u32 vcc, 0, v245
    s_waitcnt lgkmcnt(0)
    v_mfma_f32_32x32x16_bf16 v[0:15], v[208:211], a[80:83], v[0:15]
    ds_read_b128 v[212:215], v227
    v_cndmask_b32 v216, 0, v246, vcc
    v_cmp_eq_u32 vcc, 1, v245
    s_nop 1
    v_cndmask_b32 v217, 0, v246, vcc
    v_cmp_eq_u32 vcc, 2, v245
    v_mfma_f32_32x32x16_bf16 v[16:31], v[208:211], a[84:87], v[16:31]
    s_nop 0
    v_cndmask_b32 v218, 0, v246, vcc
    v_cmp_eq_u32 vcc, 3, v245
    s_nop 1
    v_cndmask_b32 v219, 0, v246, vcc
    v_cmp_eq_u32 vcc, 4, v245
    v_mfma_f32_32x32x16_bf16 v[32:47], v[208:211], a[88:91], v[32:47]
    s_nop 0
    v_cndmask_b32 v228, 0, v246, vcc
    v_cmp_eq_u32 vcc, 5, v245
    s_nop 1
    v_cndmask_b32 v229, 0, v246, vcc
    v_cmp_eq_u32 vcc, 6, v245
    v_mfma_f32_32x32x16_bf16 v[48:63], v[208:211], a[92:95], v[48:63]
    s_nop 0
    v_cndmask_b32 v230, 0, v246, vcc
    v_cmp_eq_u32 vcc, 7, v245
    s_nop 1
    v_cndmask_b32 v231, 0, v246, vcc
    v_add_u32 v224, 65536, v220
    v_add_u32 v225, 65536, v221
    v_add_u32 v226, 65536, v222
    v_add_u32 v227, 65536, v223
    s_waitcnt lgkmcnt(0)
    v_mfma_f32_32x32x16_bf16 v[0:15], v[212:215], a[96:99], v[0:15]
    ds_read_b128 v[208:211], v224
    v_mfma_f32_32x32x16_bf16 v[16:31], v[212:215], a[100:103], v[16:31]
    v_mfma_f32_32x32x16_bf16 v[32:47], v[212:215], a[104:107], v[32:47]
    v_mfma_f32_32x32x16_bf16 v[48:63], v[212:215], a[108:111], v[48:63]
    s_nop 7
    v_cvt_pk_bf16_f32 v64, v0, v1
    v_cvt_pk_bf16_f32 v65, v2, v3
    v_cvt_pk_bf16_f32 v66, v4, v5
    v_cvt_pk_bf16_f32 v67, v6, v7
    v_cvt_pk_bf16_f32 v68, v8, v9
    v_cvt_pk_bf16_f32 v69, v10, v11
    v_cvt_pk_bf16_f32 v70, v12, v13
    v_cvt_pk_bf16_f32 v71, v14, v15
    s_waitcnt lgkmcnt(0)
    v_mfma_f32_32x32x16_bf16 v[0:15], v[208:211], a[112:115], 0
    ds_read_b128 v[212:215], v225
    v_cvt_pk_bf16_f32 v72, v16, v17
    v_cvt_pk_bf16_f32 v73, v18, v19
    v_cvt_pk_bf16_f32 v74, v20, v21
    v_cvt_pk_bf16_f32 v75, v22, v23
    v_cvt_pk_bf16_f32 v76, v24, v25
    v_cvt_pk_bf16_f32 v77, v26, v27
    v_cvt_pk_bf16_f32 v78, v28, v29
    v_cvt_pk_bf16_f32 v79, v30, v31
    v_mfma_f32_32x32x16_bf16 v[16:31], v[208:211], a[116:119], 0
    v_cvt_pk_bf16_f32 v80, v32, v33
    v_cvt_pk_bf16_f32 v81, v34, v35
    v_cvt_pk_bf16_f32 v82, v36, v37
    v_cvt_pk_bf16_f32 v83, v38, v39
    v_cvt_pk_bf16_f32 v84, v40, v41
    v_cvt_pk_bf16_f32 v85, v42, v43
    v_cvt_pk_bf16_f32 v86, v44, v45
    v_cvt_pk_bf16_f32 v87, v46, v47
    v_mfma_f32_32x32x16_bf16 v[32:47], v[208:211], a[120:123], 0
    v_cvt_pk_bf16_f32 v88, v48, v49
    v_cvt_pk_bf16_f32 v89, v50, v51
    v_cvt_pk_bf16_f32 v90, v52, v53
    v_cvt_pk_bf16_f32 v91, v54, v55
    v_cvt_pk_bf16_f32 v92, v56, v57
    v_cvt_pk_bf16_f32 v93, v58, v59
    v_cvt_pk_bf16_f32 v94, v60, v61
    v_cvt_pk_bf16_f32 v95, v62, v63
    v_mfma_f32_32x32x16_bf16 v[48:63], v[208:211], a[124:127], 0
    v_mfma_f32_32x32x16_bf16 v[176:191], v[72:75], v[128:131], 0
    v_mfma_f32_32x32x16_bf16 v[176:191], v[76:79], v[132:135], v[176:191]
    v_mfma_f32_32x32x16_bf16 v[176:191], v[88:91], v[136:139], v[176:191]
    v_mfma_f32_32x32x16_bf16 v[176:191], v[92:95], v[140:143], v[176:191]
    v_mfma_f32_32x32x16_bf16 v[160:175], v[64:67], v[128:131], 0
    v_mfma_f32_32x32x16_bf16 v[160:175], v[68:71], v[132:135], v[160:175]
    s_nop 9
    ds_write_b128 v236, v[176:179] offset:0
    ds_write_b128 v236, v[180:183] offset:1024
    v_mfma_f32_32x32x16_bf16 v[160:175], v[80:83], v[136:139], v[160:175]
    ds_write_b128 v236, v[184:187] offset:2048
    v_mfma_f32_32x32x16_bf16 v[160:175], v[84:87], v[140:143], v[160:175]
    ds_write_b128 v236, v[188:191] offset:3072
    s_waitcnt lgkmcnt(0)
    s_barrier
    v_mfma_f32_32x32x16_bf16 v[0:15], v[212:215], a[128:131], v[0:15]
    ds_read_b128 v[208:211], v226
    ds_read_b128 v[192:195], v238 offset:0
    ds_read_b128 v[196:199], v238 offset:1024
    v_mfma_f32_32x32x16_bf16 v[16:31], v[212:215], a[132:135], v[16:31]
    ds_read_b128 v[200:203], v238 offset:2048
    ds_read_b128 v[204:207], v238 offset:3072
    v_mfma_f32_32x32x16_bf16 v[32:47], v[212:215], a[136:139], v[32:47]
    v_mfma_f32_32x32x16_bf16 v[48:63], v[212:215], a[140:143], v[48:63]
    s_waitcnt lgkmcnt(3)
    v_add_f32 v160, v160, v192
    v_add_f32 v161, v161, v193
    v_add_f32 v162, v162, v194
    v_add_f32 v163, v163, v195
    s_waitcnt lgkmcnt(2)
    v_add_f32 v164, v164, v196
    s_waitcnt vmcnt(1)
    s_and_b32 s3, s2, 0xfffffffc
    s_or_b32 s3, s3, s99
    s_lshl_b32 s3, s3, 2
    s_add_u32 s3, s3, s4
    s_lshl_b32 s3, s3, 7
    s_add_u32 s3, s3, 6357000
    s_mov_b64 exec, 1
    buffer_store_dwordx2 v[250:251], v242, s[56:59], s3 offen sc1
    s_mov_b64 exec, -1
    v_mfma_f32_32x32x16_bf16 v[0:15], v[208:211], a[144:147], v[0:15]
    ds_read_b128 v[212:215], v227
    v_add_f32 v165, v165, v197
    v_add_f32 v166, v166, v198
    v_add_f32 v167, v167, v199
    s_waitcnt lgkmcnt(2)
    v_add_f32 v168, v168, v200
    v_add_f32 v169, v169, v201
    v_mfma_f32_32x32x16_bf16 v[16:31], v[208:211], a[148:151], v[16:31]
    v_add_f32 v170, v170, v202
    v_add_f32 v171, v171, v203
    s_waitcnt lgkmcnt(1)
    v_add_f32 v172, v172, v204
    v_add_f32 v173, v173, v205
    v_add_f32 v174, v174, v206
    v_mfma_f32_32x32x16_bf16 v[32:47], v[208:211], a[152:155], v[32:47]
    v_add_f32 v175, v175, v207
    v_cvt_pk_bf16_f32 v160, v160, v161
    v_cvt_pk_bf16_f32 v161, v162, v163
    v_cvt_pk_bf16_f32 v162, v164, v165
    v_cvt_pk_bf16_f32 v163, v166, v167
    v_mfma_f32_32x32x16_bf16 v[48:63], v[208:211], a[156:159], v[48:63]
    v_cvt_pk_bf16_f32 v164, v168, v169
    v_cvt_pk_bf16_f32 v165, v170, v171
    v_cvt_pk_bf16_f32 v166, v172, v173
    v_cvt_pk_bf16_f32 v167, v174, v175
    s_and_b32 s3, s2, 0xfffffffc
    s_or_b32 s3, s3, s100
    s_mul_i32 s3, s3, 12
    s_add_u32 s3, s3, 8
    s_add_u32 s3, s3, s4
    s_lshl_b32 s3, s3, 11
    s_add_u32 s3, s3, 8388608
    buffer_store_dwordx4 v[160:163], v234, s[56:59], s3 offen offset:0 sc1
    buffer_store_dwordx4 v[164:167], v234, s[56:59], s3 offen offset:1024 sc1
    v_add_u32 v224, 81920, v220
    v_add_u32 v225, 81920, v221
    v_add_u32 v226, 81920, v222
    v_add_u32 v227, 81920, v223
    s_waitcnt lgkmcnt(0)
    v_mfma_f32_32x32x16_bf16 v[0:15], v[212:215], a[160:163], v[0:15]
    ds_read_b128 v[208:211], v224
    v_mfma_f32_32x32x16_bf16 v[16:31], v[212:215], a[164:167], v[16:31]
    v_mfma_f32_32x32x16_bf16 v[32:47], v[212:215], a[168:171], v[32:47]
    v_mfma_f32_32x32x16_bf16 v[48:63], v[212:215], a[172:175], v[48:63]
    s_waitcnt lgkmcnt(0)
    v_mfma_f32_32x32x16_bf16 v[0:15], v[208:211], a[176:179], v[0:15]
    ds_read_b128 v[212:215], v225
    v_mfma_f32_32x32x16_bf16 v[16:31], v[208:211], a[180:183], v[16:31]
    v_mfma_f32_32x32x16_bf16 v[32:47], v[208:211], a[184:187], v[32:47]
    v_mfma_f32_32x32x16_bf16 v[48:63], v[208:211], a[188:191], v[48:63]
    s_waitcnt lgkmcnt(0)
    v_mfma_f32_32x32x16_bf16 v[0:15], v[212:215], a[192:195], v[0:15]
    ds_read_b128 v[208:211], v226
    v_mfma_f32_32x32x16_bf16 v[16:31], v[212:215], a[196:199], v[16:31]
    v_mfma_f32_32x32x16_bf16 v[32:47], v[212:215], a[200:203], v[32:47]
    v_mfma_f32_32x32x16_bf16 v[48:63], v[212:215], a[204:207], v[48:63]
    buffer_load_dwordx4 v[244:247], v242, s[56:59], s17 offen sc1
    s_waitcnt lgkmcnt(0)
    v_mfma_f32_32x32x16_bf16 v[0:15], v[208:211], a[208:211], v[0:15]
    ds_read_b128 v[212:215], v227
    v_mfma_f32_32x32x16_bf16 v[16:31], v[208:211], a[212:215], v[16:31]
    v_mfma_f32_32x32x16_bf16 v[32:47], v[208:211], a[216:219], v[32:47]
    v_mfma_f32_32x32x16_bf16 v[48:63], v[208:211], a[220:223], v[48:63]
    v_add_u32 v224, 0, v220
    v_add_u32 v225, 0, v221
    v_add_u32 v226, 0, v222
    v_add_u32 v227, 0, v223
    s_waitcnt lgkmcnt(0)
    v_mfma_f32_32x32x16_bf16 v[0:15], v[212:215], a[224:227], v[0:15]
    ds_read_b128 v[208:211], v224
    v_mfma_f32_32x32x16_bf16 v[16:31], v[212:215], a[228:231], v[16:31]
    v_mfma_f32_32x32x16_bf16 v[32:47], v[212:215], a[232:235], v[32:47]
    v_mfma_f32_32x32x16_bf16 v[48:63], v[212:215], a[236:239], v[48:63]
    s_waitcnt lgkmcnt(0)
    v_mfma_f32_32x32x16_bf16 v[0:15], v[208:211], a[240:243], v[0:15]
    ds_read_b128 v[212:215], v225
    v_mfma_f32_32x32x16_bf16 v[16:31], v[208:211], a[244:247], v[16:31]
    v_mfma_f32_32x32x16_bf16 v[32:47], v[208:211], a[248:251], v[32:47]
    v_mfma_f32_32x32x16_bf16 v[48:63], v[208:211], a[252:255], v[48:63]
    s_waitcnt lgkmcnt(0)
    v_mfma_f32_32x32x16_bf16 v[0:15], v[212:215], a[0:3], v[0:15]
    ds_read_b128 v[208:211], v226
    v_mfma_f32_32x32x16_bf16 v[16:31], v[212:215], a[4:7], v[16:31]
    v_mfma_f32_32x32x16_bf16 v[32:47], v[212:215], a[8:11], v[32:47]
    v_mfma_f32_32x32x16_bf16 v[48:63], v[212:215], a[12:15], v[48:63]
    s_waitcnt lgkmcnt(0)
    v_mfma_f32_32x32x16_bf16 v[0:15], v[208:211], a[16:19], v[0:15]
    ds_read_b128 v[212:215], v227
    v_mfma_f32_32x32x16_bf16 v[16:31], v[208:211], a[20:23], v[16:31]
    v_mfma_f32_32x32x16_bf16 v[32:47], v[208:211], a[24:27], v[32:47]
    v_mfma_f32_32x32x16_bf16 v[48:63], v[208:211], a[28:31], v[48:63]
    v_add_u32 v224, 16384, v220
    v_add_u32 v225, 16384, v221
    v_add_u32 v226, 16384, v222
    v_add_u32 v227, 16384, v223
    s_waitcnt vmcnt(0)
    v_xor_b32 v248, v244, v250
    v_xor_b32 v249, v245, v251
    v_or_b32 v248, v248, v249
    v_xor_b32 v249, v246, v250
    v_or_b32 v248, v248, v249
    v_xor_b32 v249, v247, v251
    v_or_b32 v248, v248, v249
    v_cmp_eq_u32 vcc, 0, v248
    s_nop 3
    s_cmp_eq_u64 vcc, -1
    s_cbranch_scc0 L_slow2
L_back2:
    s_barrier
    s_waitcnt lgkmcnt(0)
    v_mfma_f32_32x32x16_bf16 v[0:15], v[212:215], a[32:35], v[0:15]
    ds_read_b128 v[208:211], v224
    v_mfma_f32_32x32x16_bf16 v[16:31], v[212:215], a[36:39], v[16:31]
    v_mfma_f32_32x32x16_bf16 v[32:47], v[212:215], a[40:43], v[32:47]
    v_mfma_f32_32x32x16_bf16 v[48:63], v[212:215], a[44:47], v[48:63]
    s_add_u32 s91, s16, 0
    buffer_load_dwordx4 v[64:67], v234, s[56:59], s91 offen offset:0 sc1
    buffer_load_dwordx4 v[68:71], v234, s[56:59], s91 offen offset:1024 sc1
    s_waitcnt lgkmcnt(0)
    v_mfma_f32_32x32x16_bf16 v[0:15], v[208:211], a[48:51], v[0:15]
    ds_read_b128 v[212:215], v225
    s_add_u32 s91, s16, 8192
    buffer_load_dwordx4 v[72:75], v234, s[56:59], s91 offen offset:0 sc1
    v_mfma_f32_32x32x16_bf16 v[16:31], v[208:211], a[52:55], v[16:31]
    buffer_load_dwordx4 v[76:79], v234, s[56:59], s91 offen offset:1024 sc1
    v_mfma_f32_32x32x16_bf16 v[32:47], v[208:211], a[56:59], v[32:47]
    s_add_u32 s91, s16, 16384
    buffer_load_dwordx4 v[80:83], v234, s[56:59], s91 offen offset:0 sc1
    v_mfma_f32_32x32x16_bf16 v[48:63], v[208:211], a[60:63], v[48:63]
    buffer_load_dwordx4 v[84:87], v234, s[56:59], s91 offen offset:1024 sc1
    s_waitcnt lgkmcnt(0)
    v_mfma_f32_32x32x16_bf16 v[0:15], v[212:215], a[64:67], v[0:15]
    ds_read_b128 v[208:211], v226
    v_mfma_f32_32x32x16_bf16 v[16:31], v[212:215], a[68:71], v[16:31]
    v_mfma_f32_32x32x16_bf16 v[32:47], v[212:215], a[72:75], v[32:47]
    v_mfma_f32_32x32x16_bf16 v[48:63], v[212:215], a[76:79], v[48:63]
    s_waitcnt lgkmcnt(0)
    v_mfma_f32_32x32x16_bf16 v[0:15], v[208:211], a[80:83], v[0:15]
    ds_read_b128 v[212:215], v227
    v_mfma_f32_32x32x16_bf16 v[16:31], v[208:211], a[84:87], v[16:31]
    v_mfma_f32_32x32x16_bf16 v[32:47], v[208:211], a[88:91], v[32:47]
    v_mfma_f32_32x32x16_bf16 v[48:63], v[208:211], a[92:95], v[48:63]
    s_waitcnt lgkmcnt(0)
    v_mfma_f32_32x32x16_bf16 v[0:15], v[212:215], a[96:99], v[0:15]
    v_mfma_f32_32x32x16_bf16 v[16:31], v[212:215], a[100:103], v[16:31]
    v_mfma_f32_32x32x16_bf16 v[32:47], v[212:215], a[104:107], v[32:47]
    v_mfma_f32_32x32x16_bf16 v[48:63], v[212:215], a[108:111], v[48:63]
    s_nop 9
    v_cvt_pk_bf16_f32 v104, v16, v17
    v_cvt_pk_bf16_f32 v105, v18, v19
    v_cvt_pk_bf16_f32 v106, v20, v21
    v_cvt_pk_bf16_f32 v107, v22, v23
    v_cvt_pk_bf16_f32 v108, v24, v25
    v_cvt_pk_bf16_f32 v109, v26, v27
    v_cvt_pk_bf16_f32 v110, v28, v29
    v_cvt_pk_bf16_f32 v111, v30, v31
    v_cvt_pk_bf16_f32 v120, v48, v49
    v_cvt_pk_bf16_f32 v121, v50, v51
    v_cvt_pk_bf16_f32 v122, v52, v53
    v_cvt_pk_bf16_f32 v123, v54, v55
    v_cvt_pk_bf16_f32 v124, v56, v57
    v_cvt_pk_bf16_f32 v125, v58, v59
    v_cvt_pk_bf16_f32 v126, v60, v61
    v_cvt_pk_bf16_f32 v127, v62, v63
    v_mfma_f32_32x32x16_bf16 v[176:191], v[104:107], v[144:147], 0
    v_cvt_pk_bf16_f32 v96, v0, v1
    v_cvt_pk_bf16_f32 v97, v2, v3
    v_cvt_pk_bf16_f32 v98, v4, v5
    v_cvt_pk_bf16_f32 v99, v6, v7
    v_mfma_f32_32x32x16_bf16 v[176:191], v[108:111], v[148:151], v[176:191]
    v_cvt_pk_bf16_f32 v100, v8, v9
    v_cvt_pk_bf16_f32 v101, v10, v11
    v_cvt_pk_bf16_f32 v102, v12, v13
    v_cvt_pk_bf16_f32 v103, v14, v15
    v_mfma_f32_32x32x16_bf16 v[176:191], v[120:123], v[152:155], v[176:191]
    v_cvt_pk_bf16_f32 v112, v32, v33
    v_cvt_pk_bf16_f32 v113, v34, v35
    v_cvt_pk_bf16_f32 v114, v36, v37
    v_cvt_pk_bf16_f32 v115, v38, v39
    v_mfma_f32_32x32x16_bf16 v[176:191], v[124:127], v[156:159], v[176:191]
    v_cvt_pk_bf16_f32 v116, v40, v41
    v_cvt_pk_bf16_f32 v117, v42, v43
    v_cvt_pk_bf16_f32 v118, v44, v45
    v_cvt_pk_bf16_f32 v119, v46, v47
    v_mfma_f32_32x32x16_bf16 v[160:175], v[96:99], v[144:147], 0
    v_mfma_f32_32x32x16_bf16 v[160:175], v[100:103], v[148:151], v[160:175]
    v_subrev_u32 v249, 98304, v236
    s_nop 4
    ds_write_b128 v249, v[176:179] offset:0
    v_mfma_f32_32x32x16_bf16 v[160:175], v[112:115], v[152:155], v[160:175]
    ds_write_b128 v249, v[180:183] offset:1024
    ds_write_b128 v249, v[184:187] offset:2048
    v_mfma_f32_32x32x16_bf16 v[160:175], v[116:119], v[156:159], v[160:175]
    ds_write_b128 v249, v[188:191] offset:3072
    s_waitcnt vmcnt(1)
    v_max3_u32 v248, v80, v81, v82
    s_waitcnt vmcnt(0)
    v_max3_u32 v248, v248, v83, v84
    v_max3_u32 v248, v248, v85, v86
    v_max_u32 v248, v248, v87
    v_cmp_ne_u32 vcc, -1, v248
    s_nop 3
    s_cmp_eq_u64 vcc, -1
    s_cbranch_scc0 L_slow5
L_back5:
    s_waitcnt lgkmcnt(0)
    s_barrier
    v_subrev_u32 v249, 98304, v238
    ds_read_b128 v[192:195], v249 offset:0
    ds_read_b128 v[196:199], v249 offset:1024
    ds_read_b128 v[200:203], v249 offset:2048
    ds_read_b128 v[204:207], v249 offset:3072
    v_mfma_f32_32x32x16_bf16 v[160:175], v[216:219], v[64:67], v[160:175]
    v_mfma_f32_32x32x16_bf16 v[160:175], v[228:231], v[68:71], v[160:175]
    v_mfma_f32_32x32x16_bf16 v[160:175], v[216:219], v[72:75], v[160:175]
    v_mfma_f32_32x32x16_bf16 v[160:175], v[228:231], v[76:79], v[160:175]
    v_mfma_f32_32x32x16_bf16 v[160:175], v[216:219], v[80:83], v[160:175]
    v_mfma_f32_32x32x16_bf16 v[160:175], v[228:231], v[84:87], v[160:175]
    s_waitcnt lgkmcnt(3)
    s_nop 10
    v_add_f32 v160, v160, v192
    v_add_f32 v161, v161, v193
    v_add_f32 v162, v162, v194
    v_add_f32 v163, v163, v195
    s_waitcnt lgkmcnt(2)
    v_add_f32 v164, v164, v196
    v_add_f32 v165, v165, v197
    v_add_f32 v166, v166, v198
    v_add_f32 v167, v167, v199
    s_waitcnt lgkmcnt(1)
    v_add_f32 v168, v168, v200
    v_add_f32 v169, v169, v201
    v_add_f32 v170, v170, v202
    v_add_f32 v171, v171, v203
    s_waitcnt lgkmcnt(0)
    v_add_f32 v172, v172, v204
    v_add_f32 v173, v173, v205
    v_add_f32 v174, v174, v206
    v_add_f32 v175, v175, v207
    v_cvt_pk_bf16_f32 v160, v160, v161
    v_cvt_pk_bf16_f32 v161, v162, v163
    v_cvt_pk_bf16_f32 v162, v164, v165
    v_cvt_pk_bf16_f32 v163, v166, v167
    v_cvt_pk_bf16_f32 v164, v168, v169
    v_cvt_pk_bf16_f32 v165, v170, v171
    v_cvt_pk_bf16_f32 v166, v172, v173
    v_cvt_pk_bf16_f32 v167, v174, v175
    buffer_store_dwordx4 v[160:163], v235, s[60:63], 0 offen offset:0 nt
    buffer_store_dwordx4 v[164:167], v235, s[60:63], 0 offen offset:32 nt
L_fin:
    s_endpgm

L_slow0:
    s_mov_b32 s90, 0
L_spin0:
    s_add_u32 s12, s12, 1
    buffer_load_dwordx2 v[250:251], v242, s[64:67], 0 offen sc1
    s_waitcnt vmcnt(0)
    v_min_u32 v248, v250, v251
    v_cmp_ne_u32 vcc, 0, v248
    s_nop 4
    s_cmp_eq_u64 vcc, -1
    s_cbranch_scc1 L_back0
    s_add_u32 s90, s90, 1
    s_cmp_lt_u32 s90, 0x8000
    s_cbranch_scc1 L_spin0
    s_branch L_back0

L_slow1:
    s_mov_b32 s90, 0
L_spin1:
    s_add_u32 s13, s13, 1
    buffer_load_dwordx2 v[244:245], v243, s[56:59], 0 offen sc1
    s_waitcnt vmcnt(0)
    v_xor_b32 v248, v244, v250
    v_xor_b32 v249, v245, v251
    v_or_b32 v248, v248, v249
    v_cmp_eq_u32 vcc, 0, v248
    s_nop 4
    s_cmp_eq_u64 vcc, -1
    s_cbranch_scc1 L_back1
    s_add_u32 s90, s90, 1
    s_cmp_lt_u32 s90, 0x8000
    s_cbranch_scc1 L_spin1
    s_branch L_back1

L_slow2:
    s_mov_b32 s90, 0
L_spin2:
    s_add_u32 s14, s14, 64
    buffer_load_dwordx4 v[244:247], v242, s[56:59], s17 offen sc1
    s_waitcnt vmcnt(0)
    v_xor_b32 v248, v244, v250
    v_xor_b32 v249, v245, v251
    v_or_b32 v248, v248, v249
    v_xor_b32 v249, v246, v250
    v_or_b32 v248, v248, v249
    v_xor_b32 v249, v247, v251
    v_or_b32 v248, v248, v249
    v_cmp_eq_u32 vcc, 0, v248
    s_nop 4
    s_cmp_eq_u64 vcc, -1
    s_cbranch_scc1 L_back2
    s_add_u32 s90, s90, 1
    s_cmp_lt_u32 s90, 0x8000
    s_cbranch_scc1 L_spin2
    s_branch L_back2

L_slow3:
    s_mov_b32 s90, 0
L_spin3:
    s_add_u32 s14, s14, 64
    s_and_b32 s3, s2, 0xfffffffc
    s_or_b32 s3, s3, s100
    s_lshl_b32 s3, s3, 2
    s_add_u32 s3, s3, s4
    s_lshl_b32 s3, s3, 7
    s_add_u32 s3, s3, 6356992
    buffer_load_dwordx2 v[244:245], v242, s[56:59], s3 offen offset:64 sc1
    s_waitcnt vmcnt(0)
    v_xor_b32 v248, v244, v250
    v_xor_b32 v249, v245, v251
    v_or_b32 v248, v248, v249
    v_cmp_eq_u32 vcc, 0, v248
    s_nop 4
    s_cmp_eq_u64 vcc, -1
    s_cbranch_scc1 L_back3
    s_add_u32 s90, s90, 1
    s_cmp_lt_u32 s90, 0x8000
    s_cbranch_scc1 L_spin3
    s_branch L_back3

L_slow5:
    s_mov_b32 s90, 0
L_spin5:
    s_add_u32 s14, s14, 1
    s_add_u32 s91, s16, 16384
    buffer_load_dwordx4 v[80:83], v234, s[56:59], s91 offen offset:0 sc1
    buffer_load_dwordx4 v[84:87], v234, s[56:59], s91 offen offset:1024 sc1
    s_waitcnt vmcnt(0)
    v_max3_u32 v248, v80, v81, v82
    v_max3_u32 v248, v248, v83, v84
    v_max3_u32 v248, v248, v85, v86
    v_max_u32 v248, v248, v87
    v_cmp_ne_u32 vcc, -1, v248
    s_nop 4
    s_cmp_eq_u64 vcc, -1
    s_cbranch_scc1 L_back5
    s_add_u32 s90, s90, 1
    s_cmp_lt_u32 s90, 0x8000
    s_cbranch_scc1 L_spin5
    s_branch L_back5
L_idle:
    s_lshl_b32 s3, s87, 20
    s_sub_u32 s50, 4194304, s3
    s_lshl_b32 s3, s89, 18
    s_add_u32 s3, s3, s97
    v_lshlrev_b32 v0, 3, v234
    buffer_load_dword v1, v0, s[48:51], s3 offen
    s_add_u32 s3, s3, 8192
    buffer_load_dword v2, v0, s[48:51], s3 offen
L_end:
    s_endpgm
.section .rodata,"a"
.p2align 6
.amdhsa_kernel concat_heads__gqa_block_cached__gqa_block_cached__near_ridge_kernel
  .amdhsa_next_free_vgpr 512
  .amdhsa_next_free_sgpr 102
  .amdhsa_accum_offset 256
  .amdhsa_group_segment_fixed_size 0
  .amdhsa_kernarg_size 104
  .amdhsa_user_sgpr_count 2
  .amdhsa_user_sgpr_kernarg_segment_ptr 1
  .amdhsa_system_sgpr_workgroup_id_x 1
.end_amdhsa_kernel
```
